```python
import torch

def _softmax(x, axis=-1):
    return torch.softmax(x, dim=axis)
def _gelu(x):
    return torch.nn.functional.gelu(x, approximate="tanh")
def _silu(x):
    return torch.nn.functional.silu(x)
def _sigmoid(x):
    return torch.sigmoid(x)
def _layernorm(x, axis=-1, eps=1e-5):
    m = x.mean(dim=axis, keepdim=True)
    v = x.var(dim=axis, keepdim=True, unbiased=False)
    return (x - m) / torch.sqrt(v + eps)
def _scatter_add(tgt, idx, src, axis=0):
    return tgt.clone().index_add_(axis, idx, src)
def _segment_sum(src, seg, n):
    out = torch.zeros((n,) + src.shape[1:], dtype=src.dtype)
    return out.index_add_(0, seg, src)
def _pad(x, pw):
    flat = tuple(v for pair in reversed(pw) for v in pair)
    return torch.nn.functional.pad(x, flat)

kernel_name = 'concat_heads__ssm_conv_s4d__linear_kernel_hedgehog__prompt'

def setup_inputs():

    _w = (lambda a: (lambda t: t.to(torch.bfloat16) if t.is_floating_point() else t)(torch.as_tensor(a)))
    def _A_setup():
        Bsz, L, D, N = 1, 2048, 448, 256
        return {
            "u": _w((lambda *s: torch.randn(*s, dtype=torch.bfloat16) * 0.05)(Bsz, L, D)),
            "log_A_real": _w((lambda *s: torch.randn(*s, dtype=torch.bfloat16) * 6.4)(D, N) * 0.5),
            "A_imag": _w((lambda *s: torch.randn(*s, dtype=torch.bfloat16) * 0.2)(D, N) * 3.14),
            "C_real": _w((lambda *s: torch.randn(*s, dtype=torch.bfloat16) * 0.8)(D, N) / N ** 0.5),
            "C_imag": _w((lambda *s: torch.randn(*s, dtype=torch.bfloat16) * 0.8)(D, N) / N ** 0.5),
            "log_dt": _w((lambda *s: torch.randn(*s, dtype=torch.bfloat16) * 0.2)(D) * 0.5 - 4.0),
            "D_skip": _w((lambda *s: torch.randn(*s, dtype=torch.bfloat16) * 0.2)(D)),
        }
    _A_in = _A_setup()

    def _B_setup():
        B, S, D, H = 1, 2048, 448, 16
        Dh = D // H
        return {
            "x": _w((lambda *s: torch.randn(*s, dtype=torch.bfloat16) * 0.4)(B, S, D)),
            "wqkv": _w((lambda *s: torch.randn(*s, dtype=torch.bfloat16) * 0.4)(D, 3 * D)),
            "w_phi": _w((lambda *s: torch.randn(*s, dtype=torch.bfloat16) * 0.4)(H, Dh, Dh) * (Dh ** -0.5)),
            "wo": _w((lambda *s: torch.randn(*s, dtype=torch.bfloat16) * 0.05)(D, D)),
        }
    _B_in = _B_setup()

    return {
        "A_u": _A_in["u"],
        "A_log_A_real": _A_in["log_A_real"],
        "A_A_imag": _A_in["A_imag"],
        "A_C_real": _A_in["C_real"],
        "A_C_imag": _A_in["C_imag"],
        "A_log_dt": _A_in["log_dt"],
        "A_D_skip": _A_in["D_skip"],
        "B_x": _B_in["x"],
        "B_wqkv": _B_in["wqkv"],
        "B_w_phi": _B_in["w_phi"],
        "B_wo": _B_in["wo"],
    }

def reference(A_u, A_log_A_real, A_A_imag, A_C_real, A_C_imag, A_log_dt, A_D_skip, B_x, B_wqkv, B_w_phi, B_wo):
    def _A_ref(u, log_A_real, A_imag, C_real, C_imag, log_dt, D_skip):
        L = u.shape[1]
        dt = torch.exp(log_dt)
        A = -torch.exp(log_A_real) + 1j * A_imag
        C = (C_real + 1j * C_imag) * dt[:, None]
        pos = (lambda x, dt: x.to(dt))(torch.arange(L), log_dt.dtype)
        P = torch.exp((A * dt[:, None])[:, :, None] * pos[None, None, :])
        K = 2.0 * torch.einsum("dn,dnl->dl", C, P).real
        L2 = 2 * L
        u_t = (lambda x, *d: x.permute(*d))(u, 0, 2, 1)
        Kf = (lambda x, *a, **k: torch.fft.rfft(x.float(), *a, **k))(K, L2)
        Uf = (lambda x, *a, **k: torch.fft.rfft(x.float(), *a, **k))(u_t, L2)
        y = (lambda x, *a, **k: torch.fft.irfft(x, *a, **k).to(torch.bfloat16))(Uf * Kf[None, :, :], L2)[:, :, :L]
        y = (lambda x, *d: x.permute(*d))(y, 0, 2, 1)
        return y + u * D_skip[None, None, :]

    def _B_ref(x, wqkv, w_phi, wo):
        B, S, D = x.shape
        H = 16; Dh = D // H
        qkv = (lambda x, *d: x.permute(*d))((x @ wqkv).reshape(B, S, 3, H, Dh), 2, 0, 3, 1, 4)
        q, k, v = qkv[0], qkv[1], qkv[2]
        pq = torch.einsum("bhsd,hdf->bhsf", q, w_phi)
        pk = torch.einsum("bhsd,hdf->bhsf", k, w_phi)
        phi_q = torch.concatenate([_softmax(pq, axis=-1), _softmax(-pq, axis=-1)], axis=-1)
        phi_k = torch.concatenate([_softmax(pk, axis=-1), _softmax(-pk, axis=-1)], axis=-1)
        kv = torch.einsum("bhsf,bhsd->bhfd", phi_k, v)
        z  = torch.einsum("bhsf->bhf", phi_k)
        num = torch.einsum("bhqf,bhfd->bhqd", phi_q, kv)
        den = torch.einsum("bhqf,bhf->bhq", phi_q, z)[..., None] + 1e-6
        o = num / den
        return (lambda x, *d: x.permute(*d))(o, 0, 2, 1, 3).reshape(B, S, D) @ wo

    a = _A_ref(A_u, A_log_A_real, A_A_imag, A_C_real, A_C_imag, A_log_dt, A_D_skip)
    b = _B_ref(B_x, B_wqkv, B_w_phi, B_wo)
    return torch.concatenate([a, b], axis=-1)
```

```asm
; @launch kernel=k1_kernel grid=(3968,1,1) block=(256,1,1) lds=16384
; @launch kernel=k2_kernel grid=(704,1,1) block=(256,1,1) lds=65536
; @launch kernel=k3_kernel grid=(128,1,1) block=(256,1,1) lds=16384
.amdgcn_target "amdgcn-amd-amdhsa--gfx950"
.text
.globl k1_kernel
.p2align 8
.type k1_kernel,@function
k1_kernel:
    s_movk_i32 s90, 0x7fff
    s_cmp_ge_u32 s2, 3968
    s_cbranch_scc1 k1_end
    s_load_dwordx2 s[8:9], s[0:1], 104
    s_waitcnt lgkmcnt(0)
    s_and_b32 s9, s9, 0xffff
    s_mov_b32 s10, 268435456
    s_mov_b32 s11, 0x00020000
    s_cmp_lt_u32 s2, 448
    s_cbranch_scc1 k1_kgen
    s_mov_b32 s20, 19173962
    v_mov_b32 v10, 0
    v_mov_b32 v11, 0
    s_cmp_lt_u32 s2, 2240
    s_cbranch_scc1 k1_ut
    s_cmp_lt_u32 s2, 3416
    s_cbranch_scc1 k1_wq
    s_cmp_lt_u32 s2, 3808
    s_cbranch_scc1 k1_wo
    s_cmp_lt_u32 s2, 3840
    s_cbranch_scc1 k1_wp
    s_sub_u32 s3, s2, 3840
    s_lshl_b32 s3, s3, 10
    v_lshlrev_b32 v1, 2, v0
    v_add_u32 v1, s3, v1
    v_add_u32 v1, 46137344, v1
    buffer_store_dword v10, v1, s[8:11], 0 offen
    s_branch k1_end
k1_ut:
    s_load_dwordx2 s[12:13], s[0:1], 0
    s_waitcnt lgkmcnt(0)
    s_and_b32 s13, s13, 0xffff
    s_mov_b32 s14, 1835008
    s_mov_b32 s15, 0x00020000
    s_sub_u32 s3, s2, 448
    s_lshl_b32 s3, s3, 8
    v_add_u32 v1, s3, v0
    v_lshrrev_b32 v2, 10, v1
    v_and_b32 v3, 1023, v1
    v_mul_u32_u24 v4, 1792, v3
    v_lshl_add_u32 v4, v2, 1, v4
    v_add_u32 v5, 896, v4
    v_lshlrev_b32 v6, 13, v2
    v_lshl_add_u32 v6, v3, 2, v6
    buffer_store_dword v10, v6, s[8:11], 0 offen
    v_add_u32 v6, 4096, v6
    s_branch k1_gather
k1_wq:
    s_load_dwordx2 s[12:13], s[0:1], 64
    s_waitcnt lgkmcnt(0)
    s_and_b32 s13, s13, 0xffff
    s_mov_b32 s14, 1204224
    s_mov_b32 s15, 0x00020000
    s_sub_u32 s3, s2, 2240
    s_lshl_b32 s3, s3, 8
    v_add_u32 v1, s3, v0
    v_mul_hi_u32 v2, v1, s20
    v_mul_u32_u24 v3, 224, v2
    v_sub_u32 v3, v1, v3
    v_mul_u32_u24 v4, 5376, v3
    v_lshl_add_u32 v4, v2, 1, v4
    v_add_u32 v5, 2688, v4
    v_lshlrev_b32 v6, 2, v1
    v_add_u32 v6, 41943040, v6
    s_branch k1_gather
k1_wo:
    s_load_dwordx2 s[12:13], s[0:1], 80
    s_waitcnt lgkmcnt(0)
    s_and_b32 s13, s13, 0xffff
    s_mov_b32 s14, 401408
    s_mov_b32 s15, 0x00020000
    s_sub_u32 s3, s2, 3416
    s_lshl_b32 s3, s3, 8
    v_add_u32 v1, s3, v0
    v_mul_hi_u32 v2, v1, s20
    v_mul_u32_u24 v3, 224, v2
    v_sub_u32 v3, v1, v3
    v_mul_u32_u24 v4, 1792, v3
    v_lshl_add_u32 v4, v2, 1, v4
    v_add_u32 v5, 896, v4
    v_lshlrev_b32 v6, 2, v1
    v_add_u32 v6, 44040192, v6
    s_branch k1_gather
k1_wp:
    s_load_dwordx2 s[12:13], s[0:1], 72
    s_waitcnt lgkmcnt(0)
    s_and_b32 s13, s13, 0xffff
    s_mov_b32 s14, 25088
    s_mov_b32 s15, 0x00020000
    s_sub_u32 s3, s2, 3808
    s_lshl_b32 s3, s3, 8
    v_add_u32 v1, s3, v0
    v_lshrrev_b32 v2, 9, v1
    v_bfe_u32 v3, v1, 4, 5
    v_and_b32 v7, 15, v1
    v_mul_u32_u24 v4, 1568, v2
    v_mul_u32_u24 v8, 112, v7
    v_add_u32 v4, v4, v8
    v_lshl_add_u32 v4, v3, 1, v4
    v_add_u32 v5, 56, v4
    v_cmp_lt_u32 vcc, 27, v3
    s_mov_b64 s[4:5], vcc
    v_cmp_lt_u32 vcc, 13, v7
    s_or_b64 vcc, vcc, s[4:5]
    v_mov_b32 v8, 0x40000000
    s_nop 1
    v_cndmask_b32 v4, v4, v8, vcc
    v_cndmask_b32 v5, v5, v8, vcc
    v_lshlrev_b32 v6, 2, v1
    v_add_u32 v6, 45088768, v6
k1_gather:
    buffer_load_ushort v10, v4, s[12:15], 0 offen
    buffer_load_ushort v11, v5, s[12:15], 0 offen
    s_waitcnt vmcnt(0)
    v_lshl_or_b32 v10, v11, 16, v10
    buffer_store_dword v10, v6, s[8:11], 0 offen
    s_branch k1_end
k1_kgen:
    s_load_dwordx2 s[12:13], s[0:1], 8
    s_waitcnt lgkmcnt(0)
    s_and_b32 s13, s13, 0xffff
    s_mov_b32 s14, 229376
    s_mov_b32 s15, 0x00020000
    s_load_dwordx2 s[16:17], s[0:1], 16
    s_waitcnt lgkmcnt(0)
    s_and_b32 s17, s17, 0xffff
    s_mov_b32 s18, 229376
    s_mov_b32 s19, 0x00020000
    s_load_dwordx2 s[24:25], s[0:1], 24
    s_waitcnt lgkmcnt(0)
    s_and_b32 s25, s25, 0xffff
    s_mov_b32 s26, 229376
    s_mov_b32 s27, 0x00020000
    s_load_dwordx2 s[28:29], s[0:1], 32
    s_waitcnt lgkmcnt(0)
    s_and_b32 s29, s29, 0xffff
    s_mov_b32 s30, 229376
    s_mov_b32 s31, 0x00020000
    s_load_dwordx2 s[32:33], s[0:1], 40
    s_waitcnt lgkmcnt(0)
    s_and_b32 s33, s33, 0xffff
    s_mov_b32 s34, 896
    s_mov_b32 s35, 0x00020000
    s_lshl_b32 s3, s2, 1
    v_mov_b32 v1, s3
    buffer_load_ushort v2, v1, s[32:35], 0 offen
    v_and_b32 v3, 15, v0
    v_lshrrev_b32 v4, 4, v0
    s_lshl_b32 s3, s2, 9
    v_lshrrev_b32 v5, 6, v0
    v_lshlrev_b32 v5, 7, v5
    v_bfe_u32 v6, v0, 4, 2
    v_lshl_add_u32 v5, v6, 1, v5
    v_add_u32 v5, s3, v5
    s_waitcnt vmcnt(0)
    v_lshlrev_b32 v2, 16, v2
    v_mul_f32 v2, 0x3fb8aa3b, v2
    v_exp_f32 v2, v2
    s_nop 0
    v_bfe_u32 v7, v2, 16, 1
    v_add3_u32 v2, v2, v7, s90
    v_and_b32 v2, 0xffff0000, v2
    v_and_b32 v7, 7, v3
    v_lshrrev_b32 v8, 3, v3
    v_lshl_add_u32 v20, v8, 7, v7
    v_and_b32 v7, 3, v3
    v_lshrrev_b32 v8, 2, v3
    v_lshlrev_b32 v8, 7, v8
    v_lshl_add_u32 v21, v7, 1, v8
    v_add_u32 v21, 0x100, v21
    v_and_b32 v7, 1, v3
    v_bfe_u32 v8, v3, 1, 2
    v_lshlrev_b32 v8, 7, v8
    v_lshl_add_u32 v22, v7, 2, v8
    v_add_u32 v22, 0x200, v22
    v_cmp_lt_u32 vcc, 7, v3
    v_lshlrev_b32 v7, 7, v3
    v_add_u32 v7, 0x400, v7
    v_mov_b32 v8, 0x800
    v_cndmask_b32 v21, v21, v22, vcc
    v_cndmask_b32 v22, v7, v8, vcc
    v_lshlrev_b32 v23, 3, v3
    v_cvt_f32_u32 v20, v20
    v_cvt_f32_u32 v21, v21
    v_cvt_f32_u32 v22, v22
    v_cvt_f32_u32 v23, v23
    v_mov_b32 v40, 0
    v_mov_b32 v41, 0
    v_mov_b32 v42, 0
    v_mov_b32 v43, 0
    v_mov_b32 v44, 0
    v_mov_b32 v45, 0
    v_mov_b32 v46, 0
    v_mov_b32 v47, 0
    v_mov_b32 v48, 0
    v_mov_b32 v49, 0
    v_mov_b32 v50, 0
    v_mov_b32 v51, 0
    s_mov_b32 s6, 0
k1_loop:
    buffer_load_ushort v24, v5, s[12:15], 0 offen
    buffer_load_ushort v25, v5, s[16:19], 0 offen
    buffer_load_ushort v26, v5, s[24:27], 0 offen
    buffer_load_ushort v27, v5, s[28:31], 0 offen
    v_add_u32 v5, 8, v5
    s_waitcnt vmcnt(0)
    v_lshlrev_b32 v24, 16, v24
    v_mul_f32 v24, 0x3fb8aa3b, v24
    v_exp_f32 v24, v24
    v_lshlrev_b32 v25, 16, v25
    v_lshlrev_b32 v26, 16, v26
    v_lshlrev_b32 v27, 16, v27
    v_bfe_u32 v7, v24, 16, 1
    v_add3_u32 v24, v24, v7, s90
    v_and_b32 v24, 0xffff0000, v24
    v_mul_f32 v24, v24, v2
    v_mul_f32 v25, v25, v2
    v_mul_f32 v26, v26, v2
    v_mul_f32 v27, v27, v2
    v_mul_f32 v28, v24, v23
    v_mul_f32 v28, 0xbfb8aa3b, v28
    v_exp_f32 v28, v28
    v_mul_f32 v29, v25, v23
    v_mul_f32 v29, 0x3e22f983, v29
    v_fract_f32 v29, v29
    v_cos_f32 v30, v29
    v_sin_f32 v31, v29
    s_nop 0
    v_mul_f32 v32, v28, v30
    v_mul_f32 v33, v28, v31
    v_mul_f32 v28, v24, v20
    v_mul_f32 v28, 0xbfb8aa3b, v28
    v_exp_f32 v28, v28
    v_mul_f32 v29, v25, v20
    v_mul_f32 v29, 0x3e22f983, v29
    v_fract_f32 v29, v29
    v_cos_f32 v30, v29
    v_sin_f32 v31, v29
    s_nop 0
    v_mul_f32 v34, v28, v30
    v_mul_f32 v35, v28, v31
    v_mul_f32 v36, v27, v35
    v_fma_f32 v36, v26, v34, -v36
    v_mul_f32 v37, v26, v35
    v_fma_f32 v37, v27, v34, v37
    v_sub_f32 v37, 0, v37
    s_nop 1
    v_mfma_f32_16x16x4_f32 v[40:43], v36, v32, v[40:43]
    v_mfma_f32_16x16x4_f32 v[40:43], v37, v33, v[40:43]
    v_mul_f32 v28, v24, v21
    v_mul_f32 v28, 0xbfb8aa3b, v28
    v_exp_f32 v28, v28
    v_mul_f32 v29, v25, v21
    v_mul_f32 v29, 0x3e22f983, v29
    v_fract_f32 v29, v29
    v_cos_f32 v30, v29
    v_sin_f32 v31, v29
    s_nop 0
    v_mul_f32 v34, v28, v30
    v_mul_f32 v35, v28, v31
    v_mul_f32 v36, v27, v35
    v_fma_f32 v36, v26, v34, -v36
    v_mul_f32 v37, v26, v35
    v_fma_f32 v37, v27, v34, v37
    v_sub_f32 v37, 0, v37
    s_nop 1
    v_mfma_f32_16x16x4_f32 v[44:47], v36, v32, v[44:47]
    v_mfma_f32_16x16x4_f32 v[44:47], v37, v33, v[44:47]
    v_mul_f32 v28, v24, v22
    v_mul_f32 v28, 0xbfb8aa3b, v28
    v_exp_f32 v28, v28
    v_mul_f32 v29, v25, v22
    v_mul_f32 v29, 0x3e22f983, v29
    v_fract_f32 v29, v29
    v_cos_f32 v30, v29
    v_sin_f32 v31, v29
    s_nop 0
    v_mul_f32 v34, v28, v30
    v_mul_f32 v35, v28, v31
    v_mul_f32 v36, v27, v35
    v_fma_f32 v36, v26, v34, -v36
    v_mul_f32 v37, v26, v35
    v_fma_f32 v37, v27, v34, v37
    v_sub_f32 v37, 0, v37
    s_nop 1
    v_mfma_f32_16x16x4_f32 v[48:51], v36, v32, v[48:51]
    v_mfma_f32_16x16x4_f32 v[48:51], v37, v33, v[48:51]
    s_add_u32 s6, s6, 1
    s_cmp_lt_u32 s6, 16
    s_cbranch_scc1 k1_loop
    s_nop 7
    s_nop 7
    s_nop 7
    v_lshrrev_b32 v7, 6, v0
    v_mul_u32_u24 v7, 3072, v7
    v_bfe_u32 v8, v0, 4, 2
    v_lshl_add_u32 v7, v8, 8, v7
    v_lshl_add_u32 v7, v3, 2, v7
    ds_write_b32 v7, v40 offset:0
    ds_write_b32 v7, v41 offset:64
    ds_write_b32 v7, v42 offset:128
    ds_write_b32 v7, v43 offset:192
    ds_write_b32 v7, v44 offset:1024
    ds_write_b32 v7, v45 offset:1088
    ds_write_b32 v7, v46 offset:1152
    ds_write_b32 v7, v47 offset:1216
    ds_write_b32 v7, v48 offset:2048
    ds_write_b32 v7, v49 offset:2112
    ds_write_b32 v7, v50 offset:2176
    ds_write_b32 v7, v51 offset:2240
    s_waitcnt lgkmcnt(0)
    s_barrier
    v_lshlrev_b32 v7, 2, v0
    ds_read_b32 v24, v7 offset:0
    ds_read_b32 v25, v7 offset:3072
    ds_read_b32 v26, v7 offset:6144
    ds_read_b32 v27, v7 offset:9216
    s_waitcnt lgkmcnt(0)
    v_add_f32 v24, v24, v25
    v_add_f32 v26, v26, v27
    v_add_f32 v24, v24, v26
    v_add_f32 v24, v24, v24
    ds_write_b32 v7, v24 offset:12288
    ds_read_b32 v24, v7 offset:1024
    ds_read_b32 v25, v7 offset:4096
    ds_read_b32 v26, v7 offset:7168
    ds_read_b32 v27, v7 offset:10240
    s_waitcnt lgkmcnt(0)
    v_add_f32 v24, v24, v25
    v_add_f32 v26, v26, v27
    v_add_f32 v24, v24, v26
    v_add_f32 v24, v24, v24
    ds_write_b32 v7, v24 offset:13312
    ds_read_b32 v24, v7 offset:2048
    ds_read_b32 v25, v7 offset:5120
    ds_read_b32 v26, v7 offset:8192
    ds_read_b32 v27, v7 offset:11264
    s_waitcnt lgkmcnt(0)
    v_add_f32 v24, v24, v25
    v_add_f32 v26, v26, v27
    v_add_f32 v24, v24, v26
    v_add_f32 v24, v24, v24
    ds_write_b32 v7, v24 offset:14336
    s_waitcnt lgkmcnt(0)
    s_barrier
    s_mul_i32 s3, s2, 67584
    s_add_u32 s3, s3, 4194304
    s_mov_b32 s6, 0
k1_exp:
    v_add_u32 v1, s6, v0
    s_mov_b32 s21, 16268816
    v_mul_hi_u32 v4, v1, s21
    v_mul_u32_u24 v6, 264, v4
    v_sub_u32 v6, v1, v6
    v_lshl_add_u32 v6, v6, 3, v4
    v_subrev_u32 v6, 64, v6
    v_subrev_u32 v8, 0, v6
    v_cvt_f32_u32 v9, v8
    v_bfe_u32 v12, v9, 16, 1
    v_add3_u32 v9, v9, v12, s90
    v_and_b32 v9, 0xffff0000, v9
    v_cvt_u32_f32 v9, v9
    v_or_b32 v12, 1, v9
    v_ffbh_u32 v12, v12
    v_sub_u32 v12, 24, v12
    v_max_i32 v12, 0, v12
    v_add_u32 v13, 7, v12
    v_lshlrev_b32 v13, v13, 1
    v_cmp_gt_u32 vcc, 0x100, v9
    v_cndmask_b32 v13, v13, 0, vcc
    v_sub_u32 v13, v9, v13
    v_and_b32 v14, 7, v13
    v_lshrrev_b32 v14, v12, v14
    v_lshrrev_b32 v15, 7, v13
    v_lshrrev_b32 v16, v12, 8
    v_mul_u32_u24 v15, v15, v16
    v_add_u32 v14, v14, v15
    v_lshlrev_b32 v15, 3, v12
    v_cmp_eq_u32 vcc, 0, v12
    v_add_u32 v15, 8, v15
    v_cndmask_b32 v15, v15, 0, vcc
    v_add_u32 v14, v14, v15
    v_bfe_u32 v15, v13, 3, 4
    v_lshl_add_u32 v14, v14, 4, v15
    v_lshlrev_b32 v14, 2, v14
    ds_read_b32 v24, v14 offset:12288
    v_cmp_gt_i32 vcc, 0, v8
    s_waitcnt lgkmcnt(0)
    v_cndmask_b32 v24, v24, 0, vcc
    v_subrev_u32 v8, 1, v6
    v_cvt_f32_u32 v9, v8
    v_bfe_u32 v12, v9, 16, 1
    v_add3_u32 v9, v9, v12, s90
    v_and_b32 v9, 0xffff0000, v9
    v_cvt_u32_f32 v9, v9
    v_or_b32 v12, 1, v9
    v_ffbh_u32 v12, v12
    v_sub_u32 v12, 24, v12
    v_max_i32 v12, 0, v12
    v_add_u32 v13, 7, v12
    v_lshlrev_b32 v13, v13, 1
    v_cmp_gt_u32 vcc, 0x100, v9
    v_cndmask_b32 v13, v13, 0, vcc
    v_sub_u32 v13, v9, v13
    v_and_b32 v14, 7, v13
    v_lshrrev_b32 v14, v12, v14
    v_lshrrev_b32 v15, 7, v13
    v_lshrrev_b32 v16, v12, 8
    v_mul_u32_u24 v15, v15, v16
    v_add_u32 v14, v14, v15
    v_lshlrev_b32 v15, 3, v12
    v_cmp_eq_u32 vcc, 0, v12
    v_add_u32 v15, 8, v15
    v_cndmask_b32 v15, v15, 0, vcc
    v_add_u32 v14, v14, v15
    v_bfe_u32 v15, v13, 3, 4
    v_lshl_add_u32 v14, v14, 4, v15
    v_lshlrev_b32 v14, 2, v14
    ds_read_b32 v25, v14 offset:12288
    v_cmp_gt_i32 vcc, 0, v8
    s_waitcnt lgkmcnt(0)
    v_cndmask_b32 v25, v25, 0, vcc
    v_subrev_u32 v8, 2, v6
    v_cvt_f32_u32 v9, v8
    v_bfe_u32 v12, v9, 16, 1
    v_add3_u32 v9, v9, v12, s90
    v_and_b32 v9, 0xffff0000, v9
    v_cvt_u32_f32 v9, v9
    v_or_b32 v12, 1, v9
    v_ffbh_u32 v12, v12
    v_sub_u32 v12, 24, v12
    v_max_i32 v12, 0, v12
    v_add_u32 v13, 7, v12
    v_lshlrev_b32 v13, v13, 1
    v_cmp_gt_u32 vcc, 0x100, v9
    v_cndmask_b32 v13, v13, 0, vcc
    v_sub_u32 v13, v9, v13
    v_and_b32 v14, 7, v13
    v_lshrrev_b32 v14, v12, v14
    v_lshrrev_b32 v15, 7, v13
    v_lshrrev_b32 v16, v12, 8
    v_mul_u32_u24 v15, v15, v16
    v_add_u32 v14, v14, v15
    v_lshlrev_b32 v15, 3, v12
    v_cmp_eq_u32 vcc, 0, v12
    v_add_u32 v15, 8, v15
    v_cndmask_b32 v15, v15, 0, vcc
    v_add_u32 v14, v14, v15
    v_bfe_u32 v15, v13, 3, 4
    v_lshl_add_u32 v14, v14, 4, v15
    v_lshlrev_b32 v14, 2, v14
    ds_read_b32 v26, v14 offset:12288
    v_cmp_gt_i32 vcc, 0, v8
    s_waitcnt lgkmcnt(0)
    v_cndmask_b32 v26, v26, 0, vcc
    v_subrev_u32 v8, 3, v6
    v_cvt_f32_u32 v9, v8
    v_bfe_u32 v12, v9, 16, 1
    v_add3_u32 v9, v9, v12, s90
    v_and_b32 v9, 0xffff0000, v9
    v_cvt_u32_f32 v9, v9
    v_or_b32 v12, 1, v9
    v_ffbh_u32 v12, v12
    v_sub_u32 v12, 24, v12
    v_max_i32 v12, 0, v12
    v_add_u32 v13, 7, v12
    v_lshlrev_b32 v13, v13, 1
    v_cmp_gt_u32 vcc, 0x100, v9
    v_cndmask_b32 v13, v13, 0, vcc
    v_sub_u32 v13, v9, v13
    v_and_b32 v14, 7, v13
    v_lshrrev_b32 v14, v12, v14
    v_lshrrev_b32 v15, 7, v13
    v_lshrrev_b32 v16, v12, 8
    v_mul_u32_u24 v15, v15, v16
    v_add_u32 v14, v14, v15
    v_lshlrev_b32 v15, 3, v12
    v_cmp_eq_u32 vcc, 0, v12
    v_add_u32 v15, 8, v15
    v_cndmask_b32 v15, v15, 0, vcc
    v_add_u32 v14, v14, v15
    v_bfe_u32 v15, v13, 3, 4
    v_lshl_add_u32 v14, v14, 4, v15
    v_lshlrev_b32 v14, 2, v14
    ds_read_b32 v27, v14 offset:12288
    v_cmp_gt_i32 vcc, 0, v8
    s_waitcnt lgkmcnt(0)
    v_cndmask_b32 v27, v27, 0, vcc
    v_subrev_u32 v8, 4, v6
    v_cvt_f32_u32 v9, v8
    v_bfe_u32 v12, v9, 16, 1
    v_add3_u32 v9, v9, v12, s90
    v_and_b32 v9, 0xffff0000, v9
    v_cvt_u32_f32 v9, v9
    v_or_b32 v12, 1, v9
    v_ffbh_u32 v12, v12
    v_sub_u32 v12, 24, v12
    v_max_i32 v12, 0, v12
    v_add_u32 v13, 7, v12
    v_lshlrev_b32 v13, v13, 1
    v_cmp_gt_u32 vcc, 0x100, v9
    v_cndmask_b32 v13, v13, 0, vcc
    v_sub_u32 v13, v9, v13
    v_and_b32 v14, 7, v13
    v_lshrrev_b32 v14, v12, v14
    v_lshrrev_b32 v15, 7, v13
    v_lshrrev_b32 v16, v12, 8
    v_mul_u32_u24 v15, v15, v16
    v_add_u32 v14, v14, v15
    v_lshlrev_b32 v15, 3, v12
    v_cmp_eq_u32 vcc, 0, v12
    v_add_u32 v15, 8, v15
    v_cndmask_b32 v15, v15, 0, vcc
    v_add_u32 v14, v14, v15
    v_bfe_u32 v15, v13, 3, 4
    v_lshl_add_u32 v14, v14, 4, v15
    v_lshlrev_b32 v14, 2, v14
    ds_read_b32 v28, v14 offset:12288
    v_cmp_gt_i32 vcc, 0, v8
    s_waitcnt lgkmcnt(0)
    v_cndmask_b32 v28, v28, 0, vcc
    v_subrev_u32 v8, 5, v6
    v_cvt_f32_u32 v9, v8
    v_bfe_u32 v12, v9, 16, 1
    v_add3_u32 v9, v9, v12, s90
    v_and_b32 v9, 0xffff0000, v9
    v_cvt_u32_f32 v9, v9
    v_or_b32 v12, 1, v9
    v_ffbh_u32 v12, v12
    v_sub_u32 v12, 24, v12
    v_max_i32 v12, 0, v12
    v_add_u32 v13, 7, v12
    v_lshlrev_b32 v13, v13, 1
    v_cmp_gt_u32 vcc, 0x100, v9
    v_cndmask_b32 v13, v13, 0, vcc
    v_sub_u32 v13, v9, v13
    v_and_b32 v14, 7, v13
    v_lshrrev_b32 v14, v12, v14
    v_lshrrev_b32 v15, 7, v13
    v_lshrrev_b32 v16, v12, 8
    v_mul_u32_u24 v15, v15, v16
    v_add_u32 v14, v14, v15
    v_lshlrev_b32 v15, 3, v12
    v_cmp_eq_u32 vcc, 0, v12
    v_add_u32 v15, 8, v15
    v_cndmask_b32 v15, v15, 0, vcc
    v_add_u32 v14, v14, v15
    v_bfe_u32 v15, v13, 3, 4
    v_lshl_add_u32 v14, v14, 4, v15
    v_lshlrev_b32 v14, 2, v14
    ds_read_b32 v29, v14 offset:12288
    v_cmp_gt_i32 vcc, 0, v8
    s_waitcnt lgkmcnt(0)
    v_cndmask_b32 v29, v29, 0, vcc
    v_subrev_u32 v8, 6, v6
    v_cvt_f32_u32 v9, v8
    v_bfe_u32 v12, v9, 16, 1
    v_add3_u32 v9, v9, v12, s90
    v_and_b32 v9, 0xffff0000, v9
    v_cvt_u32_f32 v9, v9
    v_or_b32 v12, 1, v9
    v_ffbh_u32 v12, v12
    v_sub_u32 v12, 24, v12
    v_max_i32 v12, 0, v12
    v_add_u32 v13, 7, v12
    v_lshlrev_b32 v13, v13, 1
    v_cmp_gt_u32 vcc, 0x100, v9
    v_cndmask_b32 v13, v13, 0, vcc
    v_sub_u32 v13, v9, v13
    v_and_b32 v14, 7, v13
    v_lshrrev_b32 v14, v12, v14
    v_lshrrev_b32 v15, 7, v13
    v_lshrrev_b32 v16, v12, 8
    v_mul_u32_u24 v15, v15, v16
    v_add_u32 v14, v14, v15
    v_lshlrev_b32 v15, 3, v12
    v_cmp_eq_u32 vcc, 0, v12
    v_add_u32 v15, 8, v15
    v_cndmask_b32 v15, v15, 0, vcc
    v_add_u32 v14, v14, v15
    v_bfe_u32 v15, v13, 3, 4
    v_lshl_add_u32 v14, v14, 4, v15
    v_lshlrev_b32 v14, 2, v14
    ds_read_b32 v30, v14 offset:12288
    v_cmp_gt_i32 vcc, 0, v8
    s_waitcnt lgkmcnt(0)
    v_cndmask_b32 v30, v30, 0, vcc
    v_subrev_u32 v8, 7, v6
    v_cvt_f32_u32 v9, v8
    v_bfe_u32 v12, v9, 16, 1
    v_add3_u32 v9, v9, v12, s90
    v_and_b32 v9, 0xffff0000, v9
    v_cvt_u32_f32 v9, v9
    v_or_b32 v12, 1, v9
    v_ffbh_u32 v12, v12
    v_sub_u32 v12, 24, v12
    v_max_i32 v12, 0, v12
    v_add_u32 v13, 7, v12
    v_lshlrev_b32 v13, v13, 1
    v_cmp_gt_u32 vcc, 0x100, v9
    v_cndmask_b32 v13, v13, 0, vcc
    v_sub_u32 v13, v9, v13
    v_and_b32 v14, 7, v13
    v_lshrrev_b32 v14, v12, v14
    v_lshrrev_b32 v15, 7, v13
    v_lshrrev_b32 v16, v12, 8
    v_mul_u32_u24 v15, v15, v16
    v_add_u32 v14, v14, v15
    v_lshlrev_b32 v15, 3, v12
    v_cmp_eq_u32 vcc, 0, v12
    v_add_u32 v15, 8, v15
    v_cndmask_b32 v15, v15, 0, vcc
    v_add_u32 v14, v14, v15
    v_bfe_u32 v15, v13, 3, 4
    v_lshl_add_u32 v14, v14, 4, v15
    v_lshlrev_b32 v14, 2, v14
    ds_read_b32 v31, v14 offset:12288
    v_cmp_gt_i32 vcc, 0, v8
    s_waitcnt lgkmcnt(0)
    v_cndmask_b32 v31, v31, 0, vcc
    v_bfe_u32 v12, v24, 16, 1
    v_add3_u32 v12, v24, v12, s90
    v_and_b32 v12, 0xffff0000, v12
    v_sub_f32 v32, v24, v12
    v_mov_b32 v24, v12
    v_bfe_u32 v12, v25, 16, 1
    v_add3_u32 v12, v25, v12, s90
    v_and_b32 v12, 0xffff0000, v12
    v_sub_f32 v33, v25, v12
    v_mov_b32 v25, v12
    v_bfe_u32 v12, v26, 16, 1
    v_add3_u32 v12, v26, v12, s90
    v_and_b32 v12, 0xffff0000, v12
    v_sub_f32 v34, v26, v12
    v_mov_b32 v26, v12
    v_bfe_u32 v12, v27, 16, 1
    v_add3_u32 v12, v27, v12, s90
    v_and_b32 v12, 0xffff0000, v12
    v_sub_f32 v35, v27, v12
    v_mov_b32 v27, v12
    v_bfe_u32 v12, v28, 16, 1
    v_add3_u32 v12, v28, v12, s90
    v_and_b32 v12, 0xffff0000, v12
    v_sub_f32 v36, v28, v12
    v_mov_b32 v28, v12
    v_bfe_u32 v12, v29, 16, 1
    v_add3_u32 v12, v29, v12, s90
    v_and_b32 v12, 0xffff0000, v12
    v_sub_f32 v37, v29, v12
    v_mov_b32 v29, v12
    v_bfe_u32 v12, v30, 16, 1
    v_add3_u32 v12, v30, v12, s90
    v_and_b32 v12, 0xffff0000, v12
    v_sub_f32 v38, v30, v12
    v_mov_b32 v30, v12
    v_bfe_u32 v12, v31, 16, 1
    v_add3_u32 v12, v31, v12, s90
    v_and_b32 v12, 0xffff0000, v12
    v_sub_f32 v39, v31, v12
    v_mov_b32 v31, v12
    v_cvt_pk_bf16_f32 v40, v24, v25
    v_cvt_pk_bf16_f32 v44, v32, v33
    v_cvt_pk_bf16_f32 v41, v26, v27
    v_cvt_pk_bf16_f32 v45, v34, v35
    v_cvt_pk_bf16_f32 v42, v28, v29
    v_cvt_pk_bf16_f32 v46, v36, v37
    v_cvt_pk_bf16_f32 v43, v30, v31
    v_cvt_pk_bf16_f32 v47, v38, v39
    v_lshlrev_b32 v1, 4, v1
    v_add_u32 v1, s3, v1
    v_cmp_gt_u32 vcc, 2112, v6
    s_add_u32 s7, s6, 0
    v_add_u32 v12, s6, v0
    v_cmp_gt_u32 vcc, 2112, v12
    s_and_saveexec_b64 s[22:23], vcc
    s_cbranch_execz k1_skip
    buffer_store_dwordx4 v[40:43], v1, s[8:11], 0 offen
    v_add_u32 v1, 33792, v1
    buffer_store_dwordx4 v[44:47], v1, s[8:11], 0 offen
k1_skip:
    s_mov_b64 exec, s[22:23]
    s_add_u32 s6, s6, 256
    s_cmp_lt_u32 s6, 2112
    s_cbranch_scc1 k1_exp
k1_end:
    s_endpgm
.globl k2_kernel
.p2align 8
.type k2_kernel,@function
k2_kernel:
    s_movk_i32 s90, 0x7fff
    s_cmp_ge_u32 s2, 704
    s_cbranch_scc1 k2_end
    s_load_dwordx2 s[8:9], s[0:1], 104
    s_waitcnt lgkmcnt(0)
    s_and_b32 s9, s9, 0xffff
    s_mov_b32 s10, 268435456
    s_mov_b32 s11, 0x00020000
    s_cmp_ge_u32 s2, 448
    s_cbranch_scc1 k2_b1
    s_load_dwordx2 s[12:13], s[0:1], 0
    s_waitcnt lgkmcnt(0)
    s_and_b32 s13, s13, 0xffff
    s_mov_b32 s14, 1835008
    s_mov_b32 s15, 0x00020000
    s_load_dwordx2 s[16:17], s[0:1], 48
    s_waitcnt lgkmcnt(0)
    s_and_b32 s17, s17, 0xffff
    s_mov_b32 s18, 896
    s_mov_b32 s19, 0x00020000
    s_load_dwordx2 s[24:25], s[0:1], 88
    s_waitcnt lgkmcnt(0)
    s_and_b32 s25, s25, 0xffff
    s_mov_b32 s26, 3670016
    s_mov_b32 s27, 0x00020000
    v_and_b32 v1, 31, v0
    v_bfe_u32 v2, v0, 5, 1
    v_lshrrev_b32 v3, 6, v0
    v_lshlrev_b32 v3, 3, v3
    v_sub_u32 v4, v1, v3
    v_lshlrev_b32 v4, 7, v4
    v_lshl_add_u32 v4, v2, 4, v4
    s_lshl_b32 s3, s2, 13
    s_add_u32 s3, s3, 4096
    v_add_u32 v4, s3, v4
    v_and_b32 v5, 7, v1
    v_mul_u32_u24 v5, 264, v5
    v_lshrrev_b32 v6, 3, v1
    v_add_u32 v5, v5, v6
    v_sub_u32 v5, v5, v2
    v_lshl_add_u32 v5, v3, 3, v5
    v_lshlrev_b32 v5, 4, v5
    s_mul_i32 s3, s2, 67584
    s_add_u32 s3, s3, 4194432
    v_add_u32 v5, s3, v5
    v_mov_b32 v64, 0
    v_mov_b32 v65, 0
    v_mov_b32 v66, 0
    v_mov_b32 v67, 0
    v_mov_b32 v68, 0
    v_mov_b32 v69, 0
    v_mov_b32 v70, 0
    v_mov_b32 v71, 0
    v_mov_b32 v72, 0
    v_mov_b32 v73, 0
    v_mov_b32 v74, 0
    v_mov_b32 v75, 0
    v_mov_b32 v76, 0
    v_mov_b32 v77, 0
    v_mov_b32 v78, 0
    v_mov_b32 v79, 0
    v_mov_b32 v80, 0
    v_mov_b32 v81, 0
    v_mov_b32 v82, 0
    v_mov_b32 v83, 0
    v_mov_b32 v84, 0
    v_mov_b32 v85, 0
    v_mov_b32 v86, 0
    v_mov_b32 v87, 0
    v_mov_b32 v88, 0
    v_mov_b32 v89, 0
    v_mov_b32 v90, 0
    v_mov_b32 v91, 0
    v_mov_b32 v92, 0
    v_mov_b32 v93, 0
    v_mov_b32 v94, 0
    v_mov_b32 v95, 0
    s_mov_b32 s6, 0
k2_cl:
    buffer_load_dwordx4 v[16:19], v4, s[8:11], 0 offen offset:0
    buffer_load_dwordx4 v[20:23], v4, s[8:11], 0 offen offset:32
    buffer_load_dwordx4 v[24:27], v4, s[8:11], 0 offen offset:64
    buffer_load_dwordx4 v[28:31], v4, s[8:11], 0 offen offset:96
    v_add_u32 v6, 0xffffffa0, v5
    v_add_u32 v7, 33792, v6
    buffer_load_dwordx4 v[96:99], v6, s[8:11], 0 offen offset:96
    buffer_load_dwordx4 v[100:103], v7, s[8:11], 0 offen offset:96
    buffer_load_dwordx4 v[104:107], v6, s[8:11], 0 offen offset:160
    buffer_load_dwordx4 v[108:111], v7, s[8:11], 0 offen offset:160
    buffer_load_dwordx4 v[112:115], v6, s[8:11], 0 offen offset:64
    buffer_load_dwordx4 v[116:119], v7, s[8:11], 0 offen offset:64
    buffer_load_dwordx4 v[120:123], v6, s[8:11], 0 offen offset:128
    buffer_load_dwordx4 v[124:127], v7, s[8:11], 0 offen offset:128
    buffer_load_dwordx4 v[128:131], v6, s[8:11], 0 offen offset:32
    buffer_load_dwordx4 v[132:135], v7, s[8:11], 0 offen offset:32
    buffer_load_dwordx4 v[136:139], v6, s[8:11], 0 offen offset:96
    buffer_load_dwordx4 v[140:143], v7, s[8:11], 0 offen offset:96
    buffer_load_dwordx4 v[144:147], v6, s[8:11], 0 offen offset:0
    buffer_load_dwordx4 v[148:151], v7, s[8:11], 0 offen offset:0
    buffer_load_dwordx4 v[152:155], v6, s[8:11], 0 offen offset:64
    buffer_load_dwordx4 v[156:159], v7, s[8:11], 0 offen offset:64
    s_waitcnt vmcnt(0)
    v_mfma_f32_32x32x16_bf16 v[64:79], v[96:99], v[16:19], v[64:79]
    v_mfma_f32_32x32x16_bf16 v[64:79], v[100:103], v[16:19], v[64:79]
    v_mfma_f32_32x32x16_bf16 v[80:95], v[104:107], v[16:19], v[80:95]
    v_mfma_f32_32x32x16_bf16 v[80:95], v[108:111], v[16:19], v[80:95]
    v_mfma_f32_32x32x16_bf16 v[64:79], v[112:115], v[20:23], v[64:79]
    v_mfma_f32_32x32x16_bf16 v[64:79], v[116:119], v[20:23], v[64:79]
    v_mfma_f32_32x32x16_bf16 v[80:95], v[120:123], v[20:23], v[80:95]
    v_mfma_f32_32x32x16_bf16 v[80:95], v[124:127], v[20:23], v[80:95]
    v_mfma_f32_32x32x16_bf16 v[64:79], v[128:131], v[24:27], v[64:79]
    v_mfma_f32_32x32x16_bf16 v[64:79], v[132:135], v[24:27], v[64:79]
    v_mfma_f32_32x32x16_bf16 v[80:95], v[136:139], v[24:27], v[80:95]
    v_mfma_f32_32x32x16_bf16 v[80:95], v[140:143], v[24:27], v[80:95]
    v_mfma_f32_32x32x16_bf16 v[64:79], v[144:147], v[28:31], v[64:79]
    v_mfma_f32_32x32x16_bf16 v[64:79], v[148:151], v[28:31], v[64:79]
    v_mfma_f32_32x32x16_bf16 v[80:95], v[152:155], v[28:31], v[80:95]
    v_mfma_f32_32x32x16_bf16 v[80:95], v[156:159], v[28:31], v[80:95]
    v_add_u32 v4, 0xffffff80, v4
    v_add_u32 v5, 0x80, v5
    s_add_u32 s6, s6, 1
    s_cmp_lt_u32 s6, 8
    s_cbranch_scc1 k2_cl
    s_nop 7
    s_nop 7
    s_nop 7
    v_lshrrev_b32 v3, 6, v0
    v_lshlrev_b32 v3, 13, v3
    v_lshl_add_u32 v3, v1, 2, v3
    v_lshl_add_u32 v3, v2, 9, v3
    ds_write_b32 v3, v64 offset:0
    ds_write_b32 v3, v65 offset:128
    ds_write_b32 v3, v66 offset:256
    ds_write_b32 v3, v67 offset:384
    ds_write_b32 v3, v68 offset:1024
    ds_write_b32 v3, v69 offset:1152
    ds_write_b32 v3, v70 offset:1280
    ds_write_b32 v3, v71 offset:1408
    ds_write_b32 v3, v72 offset:2048
    ds_write_b32 v3, v73 offset:2176
    ds_write_b32 v3, v74 offset:2304
    ds_write_b32 v3, v75 offset:2432
    ds_write_b32 v3, v76 offset:3072
    ds_write_b32 v3, v77 offset:3200
    ds_write_b32 v3, v78 offset:3328
    ds_write_b32 v3, v79 offset:3456
    ds_write_b32 v3, v80 offset:4096
    ds_write_b32 v3, v81 offset:4224
    ds_write_b32 v3, v82 offset:4352
    ds_write_b32 v3, v83 offset:4480
    ds_write_b32 v3, v84 offset:5120
    ds_write_b32 v3, v85 offset:5248
    ds_write_b32 v3, v86 offset:5376
    ds_write_b32 v3, v87 offset:5504
    ds_write_b32 v3, v88 offset:6144
    ds_write_b32 v3, v89 offset:6272
    ds_write_b32 v3, v90 offset:6400
    ds_write_b32 v3, v91 offset:6528
    ds_write_b32 v3, v92 offset:7168
    ds_write_b32 v3, v93 offset:7296
    ds_write_b32 v3, v94 offset:7424
    ds_write_b32 v3, v95 offset:7552
    s_waitcnt lgkmcnt(0)
    s_barrier
    s_lshl_b32 s3, s2, 1
    v_mov_b32 v8, s3
    buffer_load_ushort v9, v8, s[16:19], 0 offen
    v_and_b32 v1, 63, v0
    v_lshrrev_b32 v2, 6, v0
    v_lshlrev_b32 v3, 7, v1
    v_lshl_add_u32 v3, v2, 2, v3
    v_lshl_add_u32 v4, v2, 6, v1
    v_mul_u32_u24 v5, 896, v4
    v_add_u32 v5, s3, v5
    v_lshlrev_b32 v4, 1, v5
    v_subrev_u32 v4, s3, v4
    s_waitcnt vmcnt(0)
    v_lshlrev_b32 v9, 16, v9
    buffer_load_ushort v10, v5, s[12:15], 0 offen
    ds_read_b32 v11, v3 offset:0
    ds_read_b32 v12, v3 offset:8192
    ds_read_b32 v13, v3 offset:16384
    ds_read_b32 v14, v3 offset:24576
    s_waitcnt vmcnt(0) lgkmcnt(0)
    v_add_f32 v11, v11, v12
    v_add_f32 v13, v13, v14
    v_add_f32 v11, v11, v13
    v_lshlrev_b32 v10, 16, v10
    v_mul_f32 v10, v10, v9
    v_bfe_u32 v12, v11, 16, 1
    v_add3_u32 v11, v11, v12, s90
    v_and_b32 v11, 0xffff0000, v11
    v_bfe_u32 v12, v10, 16, 1
    v_add3_u32 v10, v10, v12, s90
    v_and_b32 v10, 0xffff0000, v10
    v_add_f32 v11, v11, v10
    v_cvt_pk_bf16_f32 v11, v11, v11
    buffer_store_short v11, v4, s[24:27], 0 offen
    v_add_u32 v5, 229376, v5
    v_add_u32 v4, 458752, v4
    buffer_load_ushort v10, v5, s[12:15], 0 offen
    ds_read_b32 v11, v3 offset:16
    ds_read_b32 v12, v3 offset:8208
    ds_read_b32 v13, v3 offset:16400
    ds_read_b32 v14, v3 offset:24592
    s_waitcnt vmcnt(0) lgkmcnt(0)
    v_add_f32 v11, v11, v12
    v_add_f32 v13, v13, v14
    v_add_f32 v11, v11, v13
    v_lshlrev_b32 v10, 16, v10
    v_mul_f32 v10, v10, v9
    v_bfe_u32 v12, v11, 16, 1
    v_add3_u32 v11, v11, v12, s90
    v_and_b32 v11, 0xffff0000, v11
    v_bfe_u32 v12, v10, 16, 1
    v_add3_u32 v10, v10, v12, s90
    v_and_b32 v10, 0xffff0000, v10
    v_add_f32 v11, v11, v10
    v_cvt_pk_bf16_f32 v11, v11, v11
    buffer_store_short v11, v4, s[24:27], 0 offen
    v_add_u32 v5, 229376, v5
    v_add_u32 v4, 458752, v4
    buffer_load_ushort v10, v5, s[12:15], 0 offen
    ds_read_b32 v11, v3 offset:32
    ds_read_b32 v12, v3 offset:8224
    ds_read_b32 v13, v3 offset:16416
    ds_read_b32 v14, v3 offset:24608
    s_waitcnt vmcnt(0) lgkmcnt(0)
    v_add_f32 v11, v11, v12
    v_add_f32 v13, v13, v14
    v_add_f32 v11, v11, v13
    v_lshlrev_b32 v10, 16, v10
    v_mul_f32 v10, v10, v9
    v_bfe_u32 v12, v11, 16, 1
    v_add3_u32 v11, v11, v12, s90
    v_and_b32 v11, 0xffff0000, v11
    v_bfe_u32 v12, v10, 16, 1
    v_add3_u32 v10, v10, v12, s90
    v_and_b32 v10, 0xffff0000, v10
    v_add_f32 v11, v11, v10
    v_cvt_pk_bf16_f32 v11, v11, v11
    buffer_store_short v11, v4, s[24:27], 0 offen
    v_add_u32 v5, 229376, v5
    v_add_u32 v4, 458752, v4
    buffer_load_ushort v10, v5, s[12:15], 0 offen
    ds_read_b32 v11, v3 offset:48
    ds_read_b32 v12, v3 offset:8240
    ds_read_b32 v13, v3 offset:16432
    ds_read_b32 v14, v3 offset:24624
    s_waitcnt vmcnt(0) lgkmcnt(0)
    v_add_f32 v11, v11, v12
    v_add_f32 v13, v13, v14
    v_add_f32 v11, v11, v13
    v_lshlrev_b32 v10, 16, v10
    v_mul_f32 v10, v10, v9
    v_bfe_u32 v12, v11, 16, 1
    v_add3_u32 v11, v11, v12, s90
    v_and_b32 v11, 0xffff0000, v11
    v_bfe_u32 v12, v10, 16, 1
    v_add3_u32 v10, v10, v12, s90
    v_and_b32 v10, 0xffff0000, v10
    v_add_f32 v11, v11, v10
    v_cvt_pk_bf16_f32 v11, v11, v11
    buffer_store_short v11, v4, s[24:27], 0 offen
    v_add_u32 v5, 229376, v5
    v_add_u32 v4, 458752, v4
    buffer_load_ushort v10, v5, s[12:15], 0 offen
    ds_read_b32 v11, v3 offset:64
    ds_read_b32 v12, v3 offset:8256
    ds_read_b32 v13, v3 offset:16448
    ds_read_b32 v14, v3 offset:24640
    s_waitcnt vmcnt(0) lgkmcnt(0)
    v_add_f32 v11, v11, v12
    v_add_f32 v13, v13, v14
    v_add_f32 v11, v11, v13
    v_lshlrev_b32 v10, 16, v10
    v_mul_f32 v10, v10, v9
    v_bfe_u32 v12, v11, 16, 1
    v_add3_u32 v11, v11, v12, s90
    v_and_b32 v11, 0xffff0000, v11
    v_bfe_u32 v12, v10, 16, 1
    v_add3_u32 v10, v10, v12, s90
    v_and_b32 v10, 0xffff0000, v10
    v_add_f32 v11, v11, v10
    v_cvt_pk_bf16_f32 v11, v11, v11
    buffer_store_short v11, v4, s[24:27], 0 offen
    v_add_u32 v5, 229376, v5
    v_add_u32 v4, 458752, v4
    buffer_load_ushort v10, v5, s[12:15], 0 offen
    ds_read_b32 v11, v3 offset:80
    ds_read_b32 v12, v3 offset:8272
    ds_read_b32 v13, v3 offset:16464
    ds_read_b32 v14, v3 offset:24656
    s_waitcnt vmcnt(0) lgkmcnt(0)
    v_add_f32 v11, v11, v12
    v_add_f32 v13, v13, v14
    v_add_f32 v11, v11, v13
    v_lshlrev_b32 v10, 16, v10
    v_mul_f32 v10, v10, v9
    v_bfe_u32 v12, v11, 16, 1
    v_add3_u32 v11, v11, v12, s90
    v_and_b32 v11, 0xffff0000, v11
    v_bfe_u32 v12, v10, 16, 1
    v_add3_u32 v10, v10, v12, s90
    v_and_b32 v10, 0xffff0000, v10
    v_add_f32 v11, v11, v10
    v_cvt_pk_bf16_f32 v11, v11, v11
    buffer_store_short v11, v4, s[24:27], 0 offen
    v_add_u32 v5, 229376, v5
    v_add_u32 v4, 458752, v4
    buffer_load_ushort v10, v5, s[12:15], 0 offen
    ds_read_b32 v11, v3 offset:96
    ds_read_b32 v12, v3 offset:8288
    ds_read_b32 v13, v3 offset:16480
    ds_read_b32 v14, v3 offset:24672
    s_waitcnt vmcnt(0) lgkmcnt(0)
    v_add_f32 v11, v11, v12
    v_add_f32 v13, v13, v14
    v_add_f32 v11, v11, v13
    v_lshlrev_b32 v10, 16, v10
    v_mul_f32 v10, v10, v9
    v_bfe_u32 v12, v11, 16, 1
    v_add3_u32 v11, v11, v12, s90
    v_and_b32 v11, 0xffff0000, v11
    v_bfe_u32 v12, v10, 16, 1
    v_add3_u32 v10, v10, v12, s90
    v_and_b32 v10, 0xffff0000, v10
    v_add_f32 v11, v11, v10
    v_cvt_pk_bf16_f32 v11, v11, v11
    buffer_store_short v11, v4, s[24:27], 0 offen
    v_add_u32 v5, 229376, v5
    v_add_u32 v4, 458752, v4
    buffer_load_ushort v10, v5, s[12:15], 0 offen
    ds_read_b32 v11, v3 offset:112
    ds_read_b32 v12, v3 offset:8304
    ds_read_b32 v13, v3 offset:16496
    ds_read_b32 v14, v3 offset:24688
    s_waitcnt vmcnt(0) lgkmcnt(0)
    v_add_f32 v11, v11, v12
    v_add_f32 v13, v13, v14
    v_add_f32 v11, v11, v13
    v_lshlrev_b32 v10, 16, v10
    v_mul_f32 v10, v10, v9
    v_bfe_u32 v12, v11, 16, 1
    v_add3_u32 v11, v11, v12, s90
    v_and_b32 v11, 0xffff0000, v11
    v_bfe_u32 v12, v10, 16, 1
    v_add3_u32 v10, v10, v12, s90
    v_and_b32 v10, 0xffff0000, v10
    v_add_f32 v11, v11, v10
    v_cvt_pk_bf16_f32 v11, v11, v11
    buffer_store_short v11, v4, s[24:27], 0 offen
    v_add_u32 v5, 229376, v5
    v_add_u32 v4, 458752, v4
    s_branch k2_end
k2_b1:
    s_load_dwordx2 s[12:13], s[0:1], 56
    s_waitcnt lgkmcnt(0)
    s_and_b32 s13, s13, 0xffff
    s_mov_b32 s14, 1835008
    s_mov_b32 s15, 0x00020000
    s_sub_u32 s4, s2, 448
    s_lshr_b32 s5, s4, 2
    s_and_b32 s4, s4, 3
    v_and_b32 v1, 15, v0
    v_bfe_u32 v2, v0, 4, 2
    v_lshrrev_b32 v3, 6, v0
    s_nop 0
    v_readfirstlane_b32 s7, v3
    v_mov_b32 v10, 0
    v_mov_b32 v11, 0
    v_lshlrev_b32 v4, 2, v0
    ds_write_b32 v4, v10 offset:0
    v_mul_u32_u24 v4, 240, v0
    ds_write_b64 v4, v[10:11] offset:224
    s_mul_i32 s3, s5, 28672
    v_mul_u32_u24 v4, 896, v1
    v_lshl_add_u32 v4, v2, 4, v4
    v_add_u32 v4, s3, v4
    s_mov_b32 s6, s7
    s_waitcnt lgkmcnt(0)
    s_barrier
b1_tl:
    s_min_u32 s20, s6, 20
    s_mul_hi_u32 s21, s20, 0x24924925
    s_mul_i32 s22, s21, 7
    s_sub_u32 s22, s20, s22
    s_mul_i32 s23, s21, 448
    s_mul_i32 s3, s4, 112
    s_add_u32 s23, s23, s3
    s_lshl_b32 s3, s22, 4
    s_add_u32 s23, s23, s3
    s_mul_i32 s23, s23, 896
    s_add_u32 s23, s23, 41943040
    v_mul_u32_u24 v5, 896, v1
    v_lshl_add_u32 v5, v2, 4, v5
    v_add_u32 v5, s23, v5
    v_mov_b32 v16, 0
    v_mov_b32 v17, 0
    v_mov_b32 v18, 0
    v_mov_b32 v19, 0
    v_mov_b32 v20, 0
    v_mov_b32 v21, 0
    v_mov_b32 v22, 0
    v_mov_b32 v23, 0
    v_add_u32 v6, 14336, v4
    buffer_load_dwordx4 v[64:67], v4, s[12:15], 0 offen offset:0
    buffer_load_dwordx4 v[68:71], v6, s[12:15], 0 offen offset:0
    buffer_load_dwordx4 v[72:75], v5, s[8:11], 0 offen offset:0
    buffer_load_dwordx4 v[76:79], v4, s[12:15], 0 offen offset:64
    buffer_load_dwordx4 v[80:83], v6, s[12:15], 0 offen offset:64
    buffer_load_dwordx4 v[84:87], v5, s[8:11], 0 offen offset:64
    buffer_load_dwordx4 v[88:91], v4, s[12:15], 0 offen offset:128
    buffer_load_dwordx4 v[92:95], v6, s[12:15], 0 offen offset:128
    buffer_load_dwordx4 v[96:99], v5, s[8:11], 0 offen offset:128
    buffer_load_dwordx4 v[100:103], v4, s[12:15], 0 offen offset:192
    buffer_load_dwordx4 v[104:107], v6, s[12:15], 0 offen offset:192
    buffer_load_dwordx4 v[108:111], v5, s[8:11], 0 offen offset:192
    buffer_load_dwordx4 v[112:115], v4, s[12:15], 0 offen offset:256
    buffer_load_dwordx4 v[116:119], v6, s[12:15], 0 offen offset:256
    buffer_load_dwordx4 v[120:123], v5, s[8:11], 0 offen offset:256
    buffer_load_dwordx4 v[124:127], v4, s[12:15], 0 offen offset:320
    buffer_load_dwordx4 v[128:131], v6, s[12:15], 0 offen offset:320
    buffer_load_dwordx4 v[132:135], v5, s[8:11], 0 offen offset:320
    buffer_load_dwordx4 v[136:139], v4, s[12:15], 0 offen offset:384
    buffer_load_dwordx4 v[140:143], v6, s[12:15], 0 offen offset:384
    buffer_load_dwordx4 v[144:147], v5, s[8:11], 0 offen offset:384
    s_waitcnt vmcnt(18)
    v_mfma_f32_16x16x32_bf16 v[16:19], v[64:67], v[72:75], v[16:19]
    v_mfma_f32_16x16x32_bf16 v[20:23], v[68:71], v[72:75], v[20:23]
    s_waitcnt vmcnt(15)
    v_mfma_f32_16x16x32_bf16 v[16:19], v[76:79], v[84:87], v[16:19]
    v_mfma_f32_16x16x32_bf16 v[20:23], v[80:83], v[84:87], v[20:23]
    s_waitcnt vmcnt(12)
    v_mfma_f32_16x16x32_bf16 v[16:19], v[88:91], v[96:99], v[16:19]
    v_mfma_f32_16x16x32_bf16 v[20:23], v[92:95], v[96:99], v[20:23]
    s_waitcnt vmcnt(9)
    v_mfma_f32_16x16x32_bf16 v[16:19], v[100:103], v[108:111], v[16:19]
    v_mfma_f32_16x16x32_bf16 v[20:23], v[104:107], v[108:111], v[20:23]
    s_waitcnt vmcnt(6)
    v_mfma_f32_16x16x32_bf16 v[16:19], v[112:115], v[120:123], v[16:19]
    v_mfma_f32_16x16x32_bf16 v[20:23], v[116:119], v[120:123], v[20:23]
    s_waitcnt vmcnt(3)
    v_mfma_f32_16x16x32_bf16 v[16:19], v[124:127], v[132:135], v[16:19]
    v_mfma_f32_16x16x32_bf16 v[20:23], v[128:131], v[132:135], v[20:23]
    s_waitcnt vmcnt(0)
    v_mfma_f32_16x16x32_bf16 v[16:19], v[136:139], v[144:147], v[16:19]
    v_mfma_f32_16x16x32_bf16 v[20:23], v[140:143], v[144:147], v[20:23]
    buffer_load_dwordx4 v[64:67], v4, s[12:15], 0 offen offset:448
    buffer_load_dwordx4 v[68:71], v6, s[12:15], 0 offen offset:448
    buffer_load_dwordx4 v[72:75], v5, s[8:11], 0 offen offset:448
    buffer_load_dwordx4 v[76:79], v4, s[12:15], 0 offen offset:512
    buffer_load_dwordx4 v[80:83], v6, s[12:15], 0 offen offset:512
    buffer_load_dwordx4 v[84:87], v5, s[8:11], 0 offen offset:512
    buffer_load_dwordx4 v[88:91], v4, s[12:15], 0 offen offset:576
    buffer_load_dwordx4 v[92:95], v6, s[12:15], 0 offen offset:576
    buffer_load_dwordx4 v[96:99], v5, s[8:11], 0 offen offset:576
    buffer_load_dwordx4 v[100:103], v4, s[12:15], 0 offen offset:640
    buffer_load_dwordx4 v[104:107], v6, s[12:15], 0 offen offset:640
    buffer_load_dwordx4 v[108:111], v5, s[8:11], 0 offen offset:640
    buffer_load_dwordx4 v[112:115], v4, s[12:15], 0 offen offset:704
    buffer_load_dwordx4 v[116:119], v6, s[12:15], 0 offen offset:704
    buffer_load_dwordx4 v[120:123], v5, s[8:11], 0 offen offset:704
    buffer_load_dwordx4 v[124:127], v4, s[12:15], 0 offen offset:768
    buffer_load_dwordx4 v[128:131], v6, s[12:15], 0 offen offset:768
    buffer_load_dwordx4 v[132:135], v5, s[8:11], 0 offen offset:768
    buffer_load_dwordx4 v[136:139], v4, s[12:15], 0 offen offset:832
    buffer_load_dwordx4 v[140:143], v6, s[12:15], 0 offen offset:832
    buffer_load_dwordx4 v[144:147], v5, s[8:11], 0 offen offset:832
    s_waitcnt vmcnt(18)
    v_mfma_f32_16x16x32_bf16 v[16:19], v[64:67], v[72:75], v[16:19]
    v_mfma_f32_16x16x32_bf16 v[20:23], v[68:71], v[72:75], v[20:23]
    s_waitcnt vmcnt(15)
    v_mfma_f32_16x16x32_bf16 v[16:19], v[76:79], v[84:87], v[16:19]
    v_mfma_f32_16x16x32_bf16 v[20:23], v[80:83], v[84:87], v[20:23]
    s_waitcnt vmcnt(12)
    v_mfma_f32_16x16x32_bf16 v[16:19], v[88:91], v[96:99], v[16:19]
    v_mfma_f32_16x16x32_bf16 v[20:23], v[92:95], v[96:99], v[20:23]
    s_waitcnt vmcnt(9)
    v_mfma_f32_16x16x32_bf16 v[16:19], v[100:103], v[108:111], v[16:19]
    v_mfma_f32_16x16x32_bf16 v[20:23], v[104:107], v[108:111], v[20:23]
    s_waitcnt vmcnt(6)
    v_mfma_f32_16x16x32_bf16 v[16:19], v[112:115], v[120:123], v[16:19]
    v_mfma_f32_16x16x32_bf16 v[20:23], v[116:119], v[120:123], v[20:23]
    s_waitcnt vmcnt(3)
    v_mfma_f32_16x16x32_bf16 v[16:19], v[124:127], v[132:135], v[16:19]
    v_mfma_f32_16x16x32_bf16 v[20:23], v[128:131], v[132:135], v[20:23]
    s_waitcnt vmcnt(0)
    v_mfma_f32_16x16x32_bf16 v[16:19], v[136:139], v[144:147], v[16:19]
    v_mfma_f32_16x16x32_bf16 v[20:23], v[140:143], v[144:147], v[20:23]
    s_nop 7
    s_nop 7
    s_cmp_eq_u32 s21, 2
    s_cbranch_scc1 b1_v
    s_mul_i32 s3, s21, 7680
    s_lshl_b32 s22, s22, 5
    s_add_u32 s3, s3, s22
    v_mul_u32_u24 v6, 960, v2
    v_lshl_add_u32 v6, v1, 1, v6
    v_add_u32 v6, s3, v6
    v_cvt_pk_bf16_f32 v24, v16, v16
    ds_write_b16 v6, v24 offset:0
    v_cvt_pk_bf16_f32 v24, v17, v17
    ds_write_b16 v6, v24 offset:240
    v_cvt_pk_bf16_f32 v24, v18, v18
    ds_write_b16 v6, v24 offset:480
    v_cvt_pk_bf16_f32 v24, v19, v19
    ds_write_b16 v6, v24 offset:720
    v_cvt_pk_bf16_f32 v24, v20, v20
    ds_write_b16 v6, v24 offset:3840
    v_cvt_pk_bf16_f32 v24, v21, v21
    ds_write_b16 v6, v24 offset:4080
    v_cvt_pk_bf16_f32 v24, v22, v22
    ds_write_b16 v6, v24 offset:4320
    v_cvt_pk_bf16_f32 v24, v23, v23
    ds_write_b16 v6, v24 offset:4560
    s_branch b1_nx
b1_v:
    s_lshl_b32 s3, s22, 10
    v_lshlrev_b32 v6, 6, v1
    v_lshl_add_u32 v6, v2, 3, v6
    v_add_u32 v6, s3, v6
    v_cvt_pk_bf16_f32 v24, v16, v17
    v_cvt_pk_bf16_f32 v25, v18, v19
    ds_write_b64 v6, v[24:25] offset:15360
    v_cvt_pk_bf16_f32 v24, v20, v21
    v_cvt_pk_bf16_f32 v25, v22, v23
    ds_write_b64 v6, v[24:25] offset:15392
b1_nx:
    s_add_u32 s6, s6, 4
    s_cmp_lt_u32 s6, 24
    s_cbranch_scc1 b1_tl
    s_waitcnt lgkmcnt(0)
    s_barrier
    v_and_b32 v60, 63, v0
    v_xor_b32 v61, 32, v60
    v_xor_b32 v60, 16, v60
    v_lshlrev_b32 v60, 2, v60
    v_lshlrev_b32 v61, 2, v61
    s_lshl_b32 s3, s4, 2
    s_add_u32 s20, s3, s7
    s_lshl_b32 s3, s20, 11
    s_add_u32 s3, s3, 45088768
    v_lshlrev_b32 v5, 6, v1
    v_lshl_add_u32 v5, v2, 4, v5
    v_add_u32 v5, s3, v5
    buffer_load_dwordx4 v[40:43], v5, s[8:11], 0 offen
    buffer_load_dwordx4 v[44:47], v5, s[8:11], 0 offen offset:1024
    s_mul_i32 s3, s7, 56
    v_mul_u32_u24 v6, 240, v1
    v_lshl_add_u32 v6, v2, 4, v6
    v_add_u32 v6, s3, v6
    v_cmp_eq_u32 s[22:23], 3, v2
    v_lshlrev_b32 v7, 3, v2
    ds_read_b64 v[24:25], v6 offset:0
    ds_read_b64 v[26:27], v6 offset:8
    s_waitcnt vmcnt(0) lgkmcnt(0)
    v_mfma_f32_16x16x32_bf16 v[16:19], v[40:43], v[24:27], 0
    v_mfma_f32_16x16x32_bf16 v[20:23], v[44:47], v[24:27], 0
    s_nop 7
    v_bfe_u32 v28, v16, 16, 1
    v_add3_u32 v16, v16, v28, s90
    v_and_b32 v16, 0xffff0000, v16
    v_bfe_u32 v28, v17, 16, 1
    v_add3_u32 v17, v17, v28, s90
    v_and_b32 v17, 0xffff0000, v17
    v_bfe_u32 v28, v18, 16, 1
    v_add3_u32 v18, v18, v28, s90
    v_and_b32 v18, 0xffff0000, v18
    v_bfe_u32 v28, v19, 16, 1
    v_add3_u32 v19, v19, v28, s90
    v_and_b32 v19, 0xffff0000, v19
    v_bfe_u32 v28, v20, 16, 1
    v_add3_u32 v20, v20, v28, s90
    v_and_b32 v20, 0xffff0000, v20
    v_bfe_u32 v28, v21, 16, 1
    v_add3_u32 v21, v21, v28, s90
    v_and_b32 v21, 0xffff0000, v21
    v_bfe_u32 v28, v22, 16, 1
    v_add3_u32 v22, v22, v28, s90
    v_and_b32 v22, 0xffff0000, v22
    v_bfe_u32 v28, v23, 16, 1
    v_add3_u32 v23, v23, v28, s90
    v_and_b32 v23, 0xffff0000, v23
    v_max3_f32 v28, v16, v17, v18
    v_max_f32 v28, v28, v19
    v_min3_f32 v29, v16, v17, v18
    v_min_f32 v29, v29, v19
    v_max3_f32 v30, v20, v21, v22
    v_max3_f32 v30, v30, v23, v28
    v_min3_f32 v31, v20, v21, v22
    v_min3_f32 v31, v31, v23, v29
    v_cndmask_b32 v28, v30, v28, s[22:23]
    v_cndmask_b32 v29, v31, v29, s[22:23]
    ds_bpermute_b32 v30, v60, v28
    s_waitcnt lgkmcnt(0)
    v_max_f32 v28, v28, v30
    ds_bpermute_b32 v30, v61, v28
    s_waitcnt lgkmcnt(0)
    v_max_f32 v28, v28, v30
    ds_bpermute_b32 v30, v60, v29
    s_waitcnt lgkmcnt(0)
    v_min_f32 v29, v29, v30
    ds_bpermute_b32 v30, v61, v29
    s_waitcnt lgkmcnt(0)
    v_min_f32 v29, v29, v30
    v_mov_b32 v30, 0
    v_mov_b32 v31, 0
    v_sub_f32 v32, v16, v28
    v_sub_f32 v48, v29, v16
    v_mul_f32 v32, 0x3fb8aa3b, v32
    v_mul_f32 v48, 0x3fb8aa3b, v48
    v_exp_f32 v32, v32
    v_exp_f32 v48, v48
    s_nop 0
    v_add_f32 v30, v30, v32
    v_add_f32 v31, v31, v48
    v_sub_f32 v33, v17, v28
    v_sub_f32 v49, v29, v17
    v_mul_f32 v33, 0x3fb8aa3b, v33
    v_mul_f32 v49, 0x3fb8aa3b, v49
    v_exp_f32 v33, v33
    v_exp_f32 v49, v49
    s_nop 0
    v_add_f32 v30, v30, v33
    v_add_f32 v31, v31, v49
    v_sub_f32 v34, v18, v28
    v_sub_f32 v50, v29, v18
    v_mul_f32 v34, 0x3fb8aa3b, v34
    v_mul_f32 v50, 0x3fb8aa3b, v50
    v_exp_f32 v34, v34
    v_exp_f32 v50, v50
    s_nop 0
    v_add_f32 v30, v30, v34
    v_add_f32 v31, v31, v50
    v_sub_f32 v35, v19, v28
    v_sub_f32 v51, v29, v19
    v_mul_f32 v35, 0x3fb8aa3b, v35
    v_mul_f32 v51, 0x3fb8aa3b, v51
    v_exp_f32 v35, v35
    v_exp_f32 v51, v51
    s_nop 0
    v_add_f32 v30, v30, v35
    v_add_f32 v31, v31, v51
    v_sub_f32 v36, v20, v28
    v_sub_f32 v52, v29, v20
    v_mul_f32 v36, 0x3fb8aa3b, v36
    v_mul_f32 v52, 0x3fb8aa3b, v52
    v_exp_f32 v36, v36
    v_exp_f32 v52, v52
    s_nop 0
    v_cndmask_b32 v36, v36, 0, s[22:23]
    v_cndmask_b32 v52, v52, 0, s[22:23]
    v_add_f32 v30, v30, v36
    v_add_f32 v31, v31, v52
    v_sub_f32 v37, v21, v28
    v_sub_f32 v53, v29, v21
    v_mul_f32 v37, 0x3fb8aa3b, v37
    v_mul_f32 v53, 0x3fb8aa3b, v53
    v_exp_f32 v37, v37
    v_exp_f32 v53, v53
    s_nop 0
    v_cndmask_b32 v37, v37, 0, s[22:23]
    v_cndmask_b32 v53, v53, 0, s[22:23]
    v_add_f32 v30, v30, v37
    v_add_f32 v31, v31, v53
    v_sub_f32 v38, v22, v28
    v_sub_f32 v54, v29, v22
    v_mul_f32 v38, 0x3fb8aa3b, v38
    v_mul_f32 v54, 0x3fb8aa3b, v54
    v_exp_f32 v38, v38
    v_exp_f32 v54, v54
    s_nop 0
    v_cndmask_b32 v38, v38, 0, s[22:23]
    v_cndmask_b32 v54, v54, 0, s[22:23]
    v_add_f32 v30, v30, v38
    v_add_f32 v31, v31, v54
    v_sub_f32 v39, v23, v28
    v_sub_f32 v55, v29, v23
    v_mul_f32 v39, 0x3fb8aa3b, v39
    v_mul_f32 v55, 0x3fb8aa3b, v55
    v_exp_f32 v39, v39
    v_exp_f32 v55, v55
    s_nop 0
    v_cndmask_b32 v39, v39, 0, s[22:23]
    v_cndmask_b32 v55, v55, 0, s[22:23]
    v_add_f32 v30, v30, v39
    v_add_f32 v31, v31, v55
    ds_bpermute_b32 v28, v60, v30
    s_waitcnt lgkmcnt(0)
    v_add_f32 v30, v30, v28
    ds_bpermute_b32 v28, v61, v30
    s_waitcnt lgkmcnt(0)
    v_add_f32 v30, v30, v28
    ds_bpermute_b32 v28, v60, v31
    s_waitcnt lgkmcnt(0)
    v_add_f32 v31, v31, v28
    ds_bpermute_b32 v28, v61, v31
    s_waitcnt lgkmcnt(0)
    v_add_f32 v31, v31, v28
    v_rcp_f32 v30, v30
    v_rcp_f32 v31, v31
    s_nop 0
    s_lshl_b32 s3, s5, 5
    v_add_u32 v8, 0, v1
    v_add_u32 v8, s3, v8
    v_lshlrev_b32 v8, 11, v8
    s_lshl_b32 s3, s20, 7
    s_add_u32 s3, s3, 47185920
    v_add_u32 v8, s3, v8
    v_add_u32 v8, v8, v7
    v_add_u32 v9, 56, v8
    v_cndmask_b32 v9, v8, v9, s[22:23]
    v_add_u32 v10, 8, v8
    v_cndmask_b32 v10, v8, v10, s[22:23]
    v_mul_f32 v32, v32, v30
    v_mul_f32 v48, v48, v31
    v_cvt_pk_bf16_f32 v32, v32, v32
    v_cvt_pk_bf16_f32 v48, v48, v48
    buffer_store_short v32, v8, s[8:11], 0 offen offset:0
    buffer_store_short v48, v8, s[8:11], 0 offen offset:56
    v_mul_f32 v33, v33, v30
    v_mul_f32 v49, v49, v31
    v_cvt_pk_bf16_f32 v33, v33, v33
    v_cvt_pk_bf16_f32 v49, v49, v49
    buffer_store_short v33, v8, s[8:11], 0 offen offset:2
    buffer_store_short v49, v8, s[8:11], 0 offen offset:58
    v_mul_f32 v34, v34, v30
    v_mul_f32 v50, v50, v31
    v_cvt_pk_bf16_f32 v34, v34, v34
    v_cvt_pk_bf16_f32 v50, v50, v50
    buffer_store_short v34, v8, s[8:11], 0 offen offset:4
    buffer_store_short v50, v8, s[8:11], 0 offen offset:60
    v_mul_f32 v35, v35, v30
    v_mul_f32 v51, v51, v31
    v_cvt_pk_bf16_f32 v35, v35, v35
    v_cvt_pk_bf16_f32 v51, v51, v51
    buffer_store_short v35, v8, s[8:11], 0 offen offset:6
    buffer_store_short v51, v8, s[8:11], 0 offen offset:62
    v_mul_f32 v36, v36, v30
    v_mul_f32 v52, v52, v31
    v_cvt_pk_bf16_f32 v36, v36, v36
    v_cvt_pk_bf16_f32 v52, v52, v52
    buffer_store_short v36, v9, s[8:11], 0 offen offset:32
    buffer_store_short v52, v10, s[8:11], 0 offen offset:88
    v_mul_f32 v37, v37, v30
    v_mul_f32 v53, v53, v31
    v_cvt_pk_bf16_f32 v37, v37, v37
    v_cvt_pk_bf16_f32 v53, v53, v53
    buffer_store_short v37, v9, s[8:11], 0 offen offset:34
    buffer_store_short v53, v10, s[8:11], 0 offen offset:90
    v_mul_f32 v38, v38, v30
    v_mul_f32 v54, v54, v31
    v_cvt_pk_bf16_f32 v38, v38, v38
    v_cvt_pk_bf16_f32 v54, v54, v54
    buffer_store_short v38, v9, s[8:11], 0 offen offset:36
    buffer_store_short v54, v10, s[8:11], 0 offen offset:92
    v_mul_f32 v39, v39, v30
    v_mul_f32 v55, v55, v31
    v_cvt_pk_bf16_f32 v39, v39, v39
    v_cvt_pk_bf16_f32 v55, v55, v55
    buffer_store_short v39, v9, s[8:11], 0 offen offset:38
    buffer_store_short v55, v10, s[8:11], 0 offen offset:94
    ds_read_b64 v[24:25], v6 offset:3840
    ds_read_b64 v[26:27], v6 offset:3848
    s_waitcnt vmcnt(0) lgkmcnt(0)
    v_mfma_f32_16x16x32_bf16 v[16:19], v[40:43], v[24:27], 0
    v_mfma_f32_16x16x32_bf16 v[20:23], v[44:47], v[24:27], 0
    s_nop 7
    v_bfe_u32 v28, v16, 16, 1
    v_add3_u32 v16, v16, v28, s90
    v_and_b32 v16, 0xffff0000, v16
    v_bfe_u32 v28, v17, 16, 1
    v_add3_u32 v17, v17, v28, s90
    v_and_b32 v17, 0xffff0000, v17
    v_bfe_u32 v28, v18, 16, 1
    v_add3_u32 v18, v18, v28, s90
    v_and_b32 v18, 0xffff0000, v18
    v_bfe_u32 v28, v19, 16, 1
    v_add3_u32 v19, v19, v28, s90
    v_and_b32 v19, 0xffff0000, v19
    v_bfe_u32 v28, v20, 16, 1
    v_add3_u32 v20, v20, v28, s90
    v_and_b32 v20, 0xffff0000, v20
    v_bfe_u32 v28, v21, 16, 1
    v_add3_u32 v21, v21, v28, s90
    v_and_b32 v21, 0xffff0000, v21
    v_bfe_u32 v28, v22, 16, 1
    v_add3_u32 v22, v22, v28, s90
    v_and_b32 v22, 0xffff0000, v22
    v_bfe_u32 v28, v23, 16, 1
    v_add3_u32 v23, v23, v28, s90
    v_and_b32 v23, 0xffff0000, v23
    v_max3_f32 v28, v16, v17, v18
    v_max_f32 v28, v28, v19
    v_min3_f32 v29, v16, v17, v18
    v_min_f32 v29, v29, v19
    v_max3_f32 v30, v20, v21, v22
    v_max3_f32 v30, v30, v23, v28
    v_min3_f32 v31, v20, v21, v22
    v_min3_f32 v31, v31, v23, v29
    v_cndmask_b32 v28, v30, v28, s[22:23]
    v_cndmask_b32 v29, v31, v29, s[22:23]
    ds_bpermute_b32 v30, v60, v28
    s_waitcnt lgkmcnt(0)
    v_max_f32 v28, v28, v30
    ds_bpermute_b32 v30, v61, v28
    s_waitcnt lgkmcnt(0)
    v_max_f32 v28, v28, v30
    ds_bpermute_b32 v30, v60, v29
    s_waitcnt lgkmcnt(0)
    v_min_f32 v29, v29, v30
    ds_bpermute_b32 v30, v61, v29
    s_waitcnt lgkmcnt(0)
    v_min_f32 v29, v29, v30
    v_mov_b32 v30, 0
    v_mov_b32 v31, 0
    v_sub_f32 v32, v16, v28
    v_sub_f32 v48, v29, v16
    v_mul_f32 v32, 0x3fb8aa3b, v32
    v_mul_f32 v48, 0x3fb8aa3b, v48
    v_exp_f32 v32, v32
    v_exp_f32 v48, v48
    s_nop 0
    v_add_f32 v30, v30, v32
    v_add_f32 v31, v31, v48
    v_sub_f32 v33, v17, v28
    v_sub_f32 v49, v29, v17
    v_mul_f32 v33, 0x3fb8aa3b, v33
    v_mul_f32 v49, 0x3fb8aa3b, v49
    v_exp_f32 v33, v33
    v_exp_f32 v49, v49
    s_nop 0
    v_add_f32 v30, v30, v33
    v_add_f32 v31, v31, v49
    v_sub_f32 v34, v18, v28
    v_sub_f32 v50, v29, v18
    v_mul_f32 v34, 0x3fb8aa3b, v34
    v_mul_f32 v50, 0x3fb8aa3b, v50
    v_exp_f32 v34, v34
    v_exp_f32 v50, v50
    s_nop 0
    v_add_f32 v30, v30, v34
    v_add_f32 v31, v31, v50
    v_sub_f32 v35, v19, v28
    v_sub_f32 v51, v29, v19
    v_mul_f32 v35, 0x3fb8aa3b, v35
    v_mul_f32 v51, 0x3fb8aa3b, v51
    v_exp_f32 v35, v35
    v_exp_f32 v51, v51
    s_nop 0
    v_add_f32 v30, v30, v35
    v_add_f32 v31, v31, v51
    v_sub_f32 v36, v20, v28
    v_sub_f32 v52, v29, v20
    v_mul_f32 v36, 0x3fb8aa3b, v36
    v_mul_f32 v52, 0x3fb8aa3b, v52
    v_exp_f32 v36, v36
    v_exp_f32 v52, v52
    s_nop 0
    v_cndmask_b32 v36, v36, 0, s[22:23]
    v_cndmask_b32 v52, v52, 0, s[22:23]
    v_add_f32 v30, v30, v36
    v_add_f32 v31, v31, v52
    v_sub_f32 v37, v21, v28
    v_sub_f32 v53, v29, v21
    v_mul_f32 v37, 0x3fb8aa3b, v37
    v_mul_f32 v53, 0x3fb8aa3b, v53
    v_exp_f32 v37, v37
    v_exp_f32 v53, v53
    s_nop 0
    v_cndmask_b32 v37, v37, 0, s[22:23]
    v_cndmask_b32 v53, v53, 0, s[22:23]
    v_add_f32 v30, v30, v37
    v_add_f32 v31, v31, v53
    v_sub_f32 v38, v22, v28
    v_sub_f32 v54, v29, v22
    v_mul_f32 v38, 0x3fb8aa3b, v38
    v_mul_f32 v54, 0x3fb8aa3b, v54
    v_exp_f32 v38, v38
    v_exp_f32 v54, v54
    s_nop 0
    v_cndmask_b32 v38, v38, 0, s[22:23]
    v_cndmask_b32 v54, v54, 0, s[22:23]
    v_add_f32 v30, v30, v38
    v_add_f32 v31, v31, v54
    v_sub_f32 v39, v23, v28
    v_sub_f32 v55, v29, v23
    v_mul_f32 v39, 0x3fb8aa3b, v39
    v_mul_f32 v55, 0x3fb8aa3b, v55
    v_exp_f32 v39, v39
    v_exp_f32 v55, v55
    s_nop 0
    v_cndmask_b32 v39, v39, 0, s[22:23]
    v_cndmask_b32 v55, v55, 0, s[22:23]
    v_add_f32 v30, v30, v39
    v_add_f32 v31, v31, v55
    ds_bpermute_b32 v28, v60, v30
    s_waitcnt lgkmcnt(0)
    v_add_f32 v30, v30, v28
    ds_bpermute_b32 v28, v61, v30
    s_waitcnt lgkmcnt(0)
    v_add_f32 v30, v30, v28
    ds_bpermute_b32 v28, v60, v31
    s_waitcnt lgkmcnt(0)
    v_add_f32 v31, v31, v28
    ds_bpermute_b32 v28, v61, v31
    s_waitcnt lgkmcnt(0)
    v_add_f32 v31, v31, v28
    v_rcp_f32 v30, v30
    v_rcp_f32 v31, v31
    s_nop 0
    s_lshl_b32 s3, s5, 5
    v_add_u32 v8, 16, v1
    v_add_u32 v8, s3, v8
    v_lshlrev_b32 v8, 11, v8
    s_lshl_b32 s3, s20, 7
    s_add_u32 s3, s3, 47185920
    v_add_u32 v8, s3, v8
    v_add_u32 v8, v8, v7
    v_add_u32 v9, 56, v8
    v_cndmask_b32 v9, v8, v9, s[22:23]
    v_add_u32 v10, 8, v8
    v_cndmask_b32 v10, v8, v10, s[22:23]
    v_mul_f32 v32, v32, v30
    v_mul_f32 v48, v48, v31
    v_cvt_pk_bf16_f32 v32, v32, v32
    v_cvt_pk_bf16_f32 v48, v48, v48
    buffer_store_short v32, v8, s[8:11], 0 offen offset:0
    buffer_store_short v48, v8, s[8:11], 0 offen offset:56
    v_mul_f32 v33, v33, v30
    v_mul_f32 v49, v49, v31
    v_cvt_pk_bf16_f32 v33, v33, v33
    v_cvt_pk_bf16_f32 v49, v49, v49
    buffer_store_short v33, v8, s[8:11], 0 offen offset:2
    buffer_store_short v49, v8, s[8:11], 0 offen offset:58
    v_mul_f32 v34, v34, v30
    v_mul_f32 v50, v50, v31
    v_cvt_pk_bf16_f32 v34, v34, v34
    v_cvt_pk_bf16_f32 v50, v50, v50
    buffer_store_short v34, v8, s[8:11], 0 offen offset:4
    buffer_store_short v50, v8, s[8:11], 0 offen offset:60
    v_mul_f32 v35, v35, v30
    v_mul_f32 v51, v51, v31
    v_cvt_pk_bf16_f32 v35, v35, v35
    v_cvt_pk_bf16_f32 v51, v51, v51
    buffer_store_short v35, v8, s[8:11], 0 offen offset:6
    buffer_store_short v51, v8, s[8:11], 0 offen offset:62
    v_mul_f32 v36, v36, v30
    v_mul_f32 v52, v52, v31
    v_cvt_pk_bf16_f32 v36, v36, v36
    v_cvt_pk_bf16_f32 v52, v52, v52
    buffer_store_short v36, v9, s[8:11], 0 offen offset:32
    buffer_store_short v52, v10, s[8:11], 0 offen offset:88
    v_mul_f32 v37, v37, v30
    v_mul_f32 v53, v53, v31
    v_cvt_pk_bf16_f32 v37, v37, v37
    v_cvt_pk_bf16_f32 v53, v53, v53
    buffer_store_short v37, v9, s[8:11], 0 offen offset:34
    buffer_store_short v53, v10, s[8:11], 0 offen offset:90
    v_mul_f32 v38, v38, v30
    v_mul_f32 v54, v54, v31
    v_cvt_pk_bf16_f32 v38, v38, v38
    v_cvt_pk_bf16_f32 v54, v54, v54
    buffer_store_short v38, v9, s[8:11], 0 offen offset:36
    buffer_store_short v54, v10, s[8:11], 0 offen offset:92
    v_mul_f32 v39, v39, v30
    v_mul_f32 v55, v55, v31
    v_cvt_pk_bf16_f32 v39, v39, v39
    v_cvt_pk_bf16_f32 v55, v55, v55
    buffer_store_short v39, v9, s[8:11], 0 offen offset:38
    buffer_store_short v55, v10, s[8:11], 0 offen offset:94
    ds_read_b64 v[24:25], v6 offset:7680
    ds_read_b64 v[26:27], v6 offset:7688
    s_waitcnt vmcnt(0) lgkmcnt(0)
    v_mfma_f32_16x16x32_bf16 v[16:19], v[40:43], v[24:27], 0
    v_mfma_f32_16x16x32_bf16 v[20:23], v[44:47], v[24:27], 0
    s_nop 7
    v_bfe_u32 v28, v16, 16, 1
    v_add3_u32 v16, v16, v28, s90
    v_and_b32 v16, 0xffff0000, v16
    v_bfe_u32 v28, v17, 16, 1
    v_add3_u32 v17, v17, v28, s90
    v_and_b32 v17, 0xffff0000, v17
    v_bfe_u32 v28, v18, 16, 1
    v_add3_u32 v18, v18, v28, s90
    v_and_b32 v18, 0xffff0000, v18
    v_bfe_u32 v28, v19, 16, 1
    v_add3_u32 v19, v19, v28, s90
    v_and_b32 v19, 0xffff0000, v19
    v_bfe_u32 v28, v20, 16, 1
    v_add3_u32 v20, v20, v28, s90
    v_and_b32 v20, 0xffff0000, v20
    v_bfe_u32 v28, v21, 16, 1
    v_add3_u32 v21, v21, v28, s90
    v_and_b32 v21, 0xffff0000, v21
    v_bfe_u32 v28, v22, 16, 1
    v_add3_u32 v22, v22, v28, s90
    v_and_b32 v22, 0xffff0000, v22
    v_bfe_u32 v28, v23, 16, 1
    v_add3_u32 v23, v23, v28, s90
    v_and_b32 v23, 0xffff0000, v23
    v_max3_f32 v28, v16, v17, v18
    v_max_f32 v28, v28, v19
    v_min3_f32 v29, v16, v17, v18
    v_min_f32 v29, v29, v19
    v_max3_f32 v30, v20, v21, v22
    v_max3_f32 v30, v30, v23, v28
    v_min3_f32 v31, v20, v21, v22
    v_min3_f32 v31, v31, v23, v29
    v_cndmask_b32 v28, v30, v28, s[22:23]
    v_cndmask_b32 v29, v31, v29, s[22:23]
    ds_bpermute_b32 v30, v60, v28
    s_waitcnt lgkmcnt(0)
    v_max_f32 v28, v28, v30
    ds_bpermute_b32 v30, v61, v28
    s_waitcnt lgkmcnt(0)
    v_max_f32 v28, v28, v30
    ds_bpermute_b32 v30, v60, v29
    s_waitcnt lgkmcnt(0)
    v_min_f32 v29, v29, v30
    ds_bpermute_b32 v30, v61, v29
    s_waitcnt lgkmcnt(0)
    v_min_f32 v29, v29, v30
    v_mov_b32 v30, 0
    v_mov_b32 v31, 0
    v_sub_f32 v32, v16, v28
    v_sub_f32 v48, v29, v16
    v_mul_f32 v32, 0x3fb8aa3b, v32
    v_mul_f32 v48, 0x3fb8aa3b, v48
    v_exp_f32 v32, v32
    v_exp_f32 v48, v48
    s_nop 0
    v_add_f32 v30, v30, v32
    v_add_f32 v31, v31, v48
    v_sub_f32 v33, v17, v28
    v_sub_f32 v49, v29, v17
    v_mul_f32 v33, 0x3fb8aa3b, v33
    v_mul_f32 v49, 0x3fb8aa3b, v49
    v_exp_f32 v33, v33
    v_exp_f32 v49, v49
    s_nop 0
    v_add_f32 v30, v30, v33
    v_add_f32 v31, v31, v49
    v_sub_f32 v34, v18, v28
    v_sub_f32 v50, v29, v18
    v_mul_f32 v34, 0x3fb8aa3b, v34
    v_mul_f32 v50, 0x3fb8aa3b, v50
    v_exp_f32 v34, v34
    v_exp_f32 v50, v50
    s_nop 0
    v_add_f32 v30, v30, v34
    v_add_f32 v31, v31, v50
    v_sub_f32 v35, v19, v28
    v_sub_f32 v51, v29, v19
    v_mul_f32 v35, 0x3fb8aa3b, v35
    v_mul_f32 v51, 0x3fb8aa3b, v51
    v_exp_f32 v35, v35
    v_exp_f32 v51, v51
    s_nop 0
    v_add_f32 v30, v30, v35
    v_add_f32 v31, v31, v51
    v_sub_f32 v36, v20, v28
    v_sub_f32 v52, v29, v20
    v_mul_f32 v36, 0x3fb8aa3b, v36
    v_mul_f32 v52, 0x3fb8aa3b, v52
    v_exp_f32 v36, v36
    v_exp_f32 v52, v52
    s_nop 0
    v_cndmask_b32 v36, v36, 0, s[22:23]
    v_cndmask_b32 v52, v52, 0, s[22:23]
    v_add_f32 v30, v30, v36
    v_add_f32 v31, v31, v52
    v_sub_f32 v37, v21, v28
    v_sub_f32 v53, v29, v21
    v_mul_f32 v37, 0x3fb8aa3b, v37
    v_mul_f32 v53, 0x3fb8aa3b, v53
    v_exp_f32 v37, v37
    v_exp_f32 v53, v53
    s_nop 0
    v_cndmask_b32 v37, v37, 0, s[22:23]
    v_cndmask_b32 v53, v53, 0, s[22:23]
    v_add_f32 v30, v30, v37
    v_add_f32 v31, v31, v53
    v_sub_f32 v38, v22, v28
    v_sub_f32 v54, v29, v22
    v_mul_f32 v38, 0x3fb8aa3b, v38
    v_mul_f32 v54, 0x3fb8aa3b, v54
    v_exp_f32 v38, v38
    v_exp_f32 v54, v54
    s_nop 0
    v_cndmask_b32 v38, v38, 0, s[22:23]
    v_cndmask_b32 v54, v54, 0, s[22:23]
    v_add_f32 v30, v30, v38
    v_add_f32 v31, v31, v54
    v_sub_f32 v39, v23, v28
    v_sub_f32 v55, v29, v23
    v_mul_f32 v39, 0x3fb8aa3b, v39
    v_mul_f32 v55, 0x3fb8aa3b, v55
    v_exp_f32 v39, v39
    v_exp_f32 v55, v55
    s_nop 0
    v_cndmask_b32 v39, v39, 0, s[22:23]
    v_cndmask_b32 v55, v55, 0, s[22:23]
    v_add_f32 v30, v30, v39
    v_add_f32 v31, v31, v55
    ds_bpermute_b32 v28, v60, v30
    s_waitcnt lgkmcnt(0)
    v_add_f32 v30, v30, v28
    ds_bpermute_b32 v28, v61, v30
    s_waitcnt lgkmcnt(0)
    v_add_f32 v30, v30, v28
    ds_bpermute_b32 v28, v60, v31
    s_waitcnt lgkmcnt(0)
    v_add_f32 v31, v31, v28
    ds_bpermute_b32 v28, v61, v31
    s_waitcnt lgkmcnt(0)
    v_add_f32 v31, v31, v28
    v_rcp_f32 v30, v30
    v_rcp_f32 v31, v31
    s_nop 0
    s_lshl_b32 s3, s7, 12
    v_lshlrev_b32 v8, 1, v1
    v_add_u32 v8, s3, v8
    v_lshl_add_u32 v8, v2, 8, v8
    v_add_u32 v9, 1792, v8
    v_cndmask_b32 v9, v8, v9, s[22:23]
    v_add_u32 v10, 256, v8
    v_cndmask_b32 v10, v8, v10, s[22:23]
    v_mul_f32 v32, v32, v30
    v_mul_f32 v48, v48, v31
    v_cvt_pk_bf16_f32 v32, v32, v32
    v_cvt_pk_bf16_f32 v48, v48, v48
    ds_write_b16 v8, v32 offset:22528
    ds_write_b16 v8, v48 offset:24320
    v_mul_f32 v33, v33, v30
    v_mul_f32 v49, v49, v31
    v_cvt_pk_bf16_f32 v33, v33, v33
    v_cvt_pk_bf16_f32 v49, v49, v49
    ds_write_b16 v8, v33 offset:22592
    ds_write_b16 v8, v49 offset:24384
    v_mul_f32 v34, v34, v30
    v_mul_f32 v50, v50, v31
    v_cvt_pk_bf16_f32 v34, v34, v34
    v_cvt_pk_bf16_f32 v50, v50, v50
    ds_write_b16 v8, v34 offset:22656
    ds_write_b16 v8, v50 offset:24448
    v_mul_f32 v35, v35, v30
    v_mul_f32 v51, v51, v31
    v_cvt_pk_bf16_f32 v35, v35, v35
    v_cvt_pk_bf16_f32 v51, v51, v51
    ds_write_b16 v8, v35 offset:22720
    ds_write_b16 v8, v51 offset:24512
    v_mul_f32 v36, v36, v30
    v_mul_f32 v52, v52, v31
    v_cvt_pk_bf16_f32 v36, v36, v36
    v_cvt_pk_bf16_f32 v52, v52, v52
    ds_write_b16 v9, v36 offset:23552
    ds_write_b16 v10, v52 offset:25344
    v_mul_f32 v37, v37, v30
    v_mul_f32 v53, v53, v31
    v_cvt_pk_bf16_f32 v37, v37, v37
    v_cvt_pk_bf16_f32 v53, v53, v53
    ds_write_b16 v9, v37 offset:23616
    ds_write_b16 v10, v53 offset:25408
    v_mul_f32 v38, v38, v30
    v_mul_f32 v54, v54, v31
    v_cvt_pk_bf16_f32 v38, v38, v38
    v_cvt_pk_bf16_f32 v54, v54, v54
    ds_write_b16 v9, v38 offset:23680
    ds_write_b16 v10, v54 offset:25472
    v_mul_f32 v39, v39, v30
    v_mul_f32 v55, v55, v31
    v_cvt_pk_bf16_f32 v39, v39, v39
    v_cvt_pk_bf16_f32 v55, v55, v55
    ds_write_b16 v9, v39 offset:23744
    ds_write_b16 v10, v55 offset:25536
    ds_read_b64 v[24:25], v6 offset:11520
    ds_read_b64 v[26:27], v6 offset:11528
    s_waitcnt vmcnt(0) lgkmcnt(0)
    v_mfma_f32_16x16x32_bf16 v[16:19], v[40:43], v[24:27], 0
    v_mfma_f32_16x16x32_bf16 v[20:23], v[44:47], v[24:27], 0
    s_nop 7
    v_bfe_u32 v28, v16, 16, 1
    v_add3_u32 v16, v16, v28, s90
    v_and_b32 v16, 0xffff0000, v16
    v_bfe_u32 v28, v17, 16, 1
    v_add3_u32 v17, v17, v28, s90
    v_and_b32 v17, 0xffff0000, v17
    v_bfe_u32 v28, v18, 16, 1
    v_add3_u32 v18, v18, v28, s90
    v_and_b32 v18, 0xffff0000, v18
    v_bfe_u32 v28, v19, 16, 1
    v_add3_u32 v19, v19, v28, s90
    v_and_b32 v19, 0xffff0000, v19
    v_bfe_u32 v28, v20, 16, 1
    v_add3_u32 v20, v20, v28, s90
    v_and_b32 v20, 0xffff0000, v20
    v_bfe_u32 v28, v21, 16, 1
    v_add3_u32 v21, v21, v28, s90
    v_and_b32 v21, 0xffff0000, v21
    v_bfe_u32 v28, v22, 16, 1
    v_add3_u32 v22, v22, v28, s90
    v_and_b32 v22, 0xffff0000, v22
    v_bfe_u32 v28, v23, 16, 1
    v_add3_u32 v23, v23, v28, s90
    v_and_b32 v23, 0xffff0000, v23
    v_max3_f32 v28, v16, v17, v18
    v_max_f32 v28, v28, v19
    v_min3_f32 v29, v16, v17, v18
    v_min_f32 v29, v29, v19
    v_max3_f32 v30, v20, v21, v22
    v_max3_f32 v30, v30, v23, v28
    v_min3_f32 v31, v20, v21, v22
    v_min3_f32 v31, v31, v23, v29
    v_cndmask_b32 v28, v30, v28, s[22:23]
    v_cndmask_b32 v29, v31, v29, s[22:23]
    ds_bpermute_b32 v30, v60, v28
    s_waitcnt lgkmcnt(0)
    v_max_f32 v28, v28, v30
    ds_bpermute_b32 v30, v61, v28
    s_waitcnt lgkmcnt(0)
    v_max_f32 v28, v28, v30
    ds_bpermute_b32 v30, v60, v29
    s_waitcnt lgkmcnt(0)
    v_min_f32 v29, v29, v30
    ds_bpermute_b32 v30, v61, v29
    s_waitcnt lgkmcnt(0)
    v_min_f32 v29, v29, v30
    v_mov_b32 v30, 0
    v_mov_b32 v31, 0
    v_sub_f32 v32, v16, v28
    v_sub_f32 v48, v29, v16
    v_mul_f32 v32, 0x3fb8aa3b, v32
    v_mul_f32 v48, 0x3fb8aa3b, v48
    v_exp_f32 v32, v32
    v_exp_f32 v48, v48
    s_nop 0
    v_add_f32 v30, v30, v32
    v_add_f32 v31, v31, v48
    v_sub_f32 v33, v17, v28
    v_sub_f32 v49, v29, v17
    v_mul_f32 v33, 0x3fb8aa3b, v33
    v_mul_f32 v49, 0x3fb8aa3b, v49
    v_exp_f32 v33, v33
    v_exp_f32 v49, v49
    s_nop 0
    v_add_f32 v30, v30, v33
    v_add_f32 v31, v31, v49
    v_sub_f32 v34, v18, v28
    v_sub_f32 v50, v29, v18
    v_mul_f32 v34, 0x3fb8aa3b, v34
    v_mul_f32 v50, 0x3fb8aa3b, v50
    v_exp_f32 v34, v34
    v_exp_f32 v50, v50
    s_nop 0
    v_add_f32 v30, v30, v34
    v_add_f32 v31, v31, v50
    v_sub_f32 v35, v19, v28
    v_sub_f32 v51, v29, v19
    v_mul_f32 v35, 0x3fb8aa3b, v35
    v_mul_f32 v51, 0x3fb8aa3b, v51
    v_exp_f32 v35, v35
    v_exp_f32 v51, v51
    s_nop 0
    v_add_f32 v30, v30, v35
    v_add_f32 v31, v31, v51
    v_sub_f32 v36, v20, v28
    v_sub_f32 v52, v29, v20
    v_mul_f32 v36, 0x3fb8aa3b, v36
    v_mul_f32 v52, 0x3fb8aa3b, v52
    v_exp_f32 v36, v36
    v_exp_f32 v52, v52
    s_nop 0
    v_cndmask_b32 v36, v36, 0, s[22:23]
    v_cndmask_b32 v52, v52, 0, s[22:23]
    v_add_f32 v30, v30, v36
    v_add_f32 v31, v31, v52
    v_sub_f32 v37, v21, v28
    v_sub_f32 v53, v29, v21
    v_mul_f32 v37, 0x3fb8aa3b, v37
    v_mul_f32 v53, 0x3fb8aa3b, v53
    v_exp_f32 v37, v37
    v_exp_f32 v53, v53
    s_nop 0
    v_cndmask_b32 v37, v37, 0, s[22:23]
    v_cndmask_b32 v53, v53, 0, s[22:23]
    v_add_f32 v30, v30, v37
    v_add_f32 v31, v31, v53
    v_sub_f32 v38, v22, v28
    v_sub_f32 v54, v29, v22
    v_mul_f32 v38, 0x3fb8aa3b, v38
    v_mul_f32 v54, 0x3fb8aa3b, v54
    v_exp_f32 v38, v38
    v_exp_f32 v54, v54
    s_nop 0
    v_cndmask_b32 v38, v38, 0, s[22:23]
    v_cndmask_b32 v54, v54, 0, s[22:23]
    v_add_f32 v30, v30, v38
    v_add_f32 v31, v31, v54
    v_sub_f32 v39, v23, v28
    v_sub_f32 v55, v29, v23
    v_mul_f32 v39, 0x3fb8aa3b, v39
    v_mul_f32 v55, 0x3fb8aa3b, v55
    v_exp_f32 v39, v39
    v_exp_f32 v55, v55
    s_nop 0
    v_cndmask_b32 v39, v39, 0, s[22:23]
    v_cndmask_b32 v55, v55, 0, s[22:23]
    v_add_f32 v30, v30, v39
    v_add_f32 v31, v31, v55
    ds_bpermute_b32 v28, v60, v30
    s_waitcnt lgkmcnt(0)
    v_add_f32 v30, v30, v28
    ds_bpermute_b32 v28, v61, v30
    s_waitcnt lgkmcnt(0)
    v_add_f32 v30, v30, v28
    ds_bpermute_b32 v28, v60, v31
    s_waitcnt lgkmcnt(0)
    v_add_f32 v31, v31, v28
    ds_bpermute_b32 v28, v61, v31
    s_waitcnt lgkmcnt(0)
    v_add_f32 v31, v31, v28
    v_rcp_f32 v30, v30
    v_rcp_f32 v31, v31
    s_nop 0
    s_lshl_b32 s3, s7, 12
    v_lshlrev_b32 v8, 1, v1
    v_add_u32 v8, s3, v8
    v_lshl_add_u32 v8, v2, 8, v8
    v_add_u32 v9, 1792, v8
    v_cndmask_b32 v9, v8, v9, s[22:23]
    v_add_u32 v10, 256, v8
    v_cndmask_b32 v10, v8, v10, s[22:23]
    v_mul_f32 v32, v32, v30
    v_mul_f32 v48, v48, v31
    v_cvt_pk_bf16_f32 v32, v32, v32
    v_cvt_pk_bf16_f32 v48, v48, v48
    ds_write_b16 v8, v32 offset:22560
    ds_write_b16 v8, v48 offset:24352
    v_mul_f32 v33, v33, v30
    v_mul_f32 v49, v49, v31
    v_cvt_pk_bf16_f32 v33, v33, v33
    v_cvt_pk_bf16_f32 v49, v49, v49
    ds_write_b16 v8, v33 offset:22624
    ds_write_b16 v8, v49 offset:24416
    v_mul_f32 v34, v34, v30
    v_mul_f32 v50, v50, v31
    v_cvt_pk_bf16_f32 v34, v34, v34
    v_cvt_pk_bf16_f32 v50, v50, v50
    ds_write_b16 v8, v34 offset:22688
    ds_write_b16 v8, v50 offset:24480
    v_mul_f32 v35, v35, v30
    v_mul_f32 v51, v51, v31
    v_cvt_pk_bf16_f32 v35, v35, v35
    v_cvt_pk_bf16_f32 v51, v51, v51
    ds_write_b16 v8, v35 offset:22752
    ds_write_b16 v8, v51 offset:24544
    v_mul_f32 v36, v36, v30
    v_mul_f32 v52, v52, v31
    v_cvt_pk_bf16_f32 v36, v36, v36
    v_cvt_pk_bf16_f32 v52, v52, v52
    ds_write_b16 v9, v36 offset:23584
    ds_write_b16 v10, v52 offset:25376
    v_mul_f32 v37, v37, v30
    v_mul_f32 v53, v53, v31
    v_cvt_pk_bf16_f32 v37, v37, v37
    v_cvt_pk_bf16_f32 v53, v53, v53
    ds_write_b16 v9, v37 offset:23648
    ds_write_b16 v10, v53 offset:25440
    v_mul_f32 v38, v38, v30
    v_mul_f32 v54, v54, v31
    v_cvt_pk_bf16_f32 v38, v38, v38
    v_cvt_pk_bf16_f32 v54, v54, v54
    ds_write_b16 v9, v38 offset:23712
    ds_write_b16 v10, v54 offset:25504
    v_mul_f32 v39, v39, v30
    v_mul_f32 v55, v55, v31
    v_cvt_pk_bf16_f32 v39, v39, v39
    v_cvt_pk_bf16_f32 v55, v55, v55
    ds_write_b16 v9, v39 offset:23776
    ds_write_b16 v10, v55 offset:25568
    s_waitcnt lgkmcnt(0)
    s_barrier
    s_lshl_b32 s3, s7, 12
    v_lshlrev_b32 v5, 6, v1
    v_lshl_add_u32 v5, v2, 4, v5
    v_add_u32 v6, s3, v5
    s_mul_i32 s3, s7, 1792
    v_add_u32 v5, s3, v5
    ds_read_b128 v[32:35], v5 offset:15360
    ds_read_b128 v[36:39], v5 offset:16384
    v_cmp_lt_u32 vcc, 11, v1
    v_mov_b32 v8, 0x3f803f80
    s_lshl_b32 s3, s20, 13
    s_add_u32 s3, s3, 46137344
    v_lshlrev_b32 v7, 9, v2
    v_lshl_add_u32 v7, v1, 2, v7
    v_add_u32 v7, s3, v7
    s_waitcnt lgkmcnt(0)
    v_cndmask_b32 v36, v36, v8, vcc
    v_cndmask_b32 v37, v37, v8, vcc
    v_cndmask_b32 v38, v38, v8, vcc
    v_cndmask_b32 v39, v39, v8, vcc
    ds_read_b128 v[24:27], v6 offset:22528
    s_waitcnt lgkmcnt(0)
    v_mfma_f32_16x16x32_bf16 v[16:19], v[24:27], v[32:35], 0
    v_mfma_f32_16x16x32_bf16 v[20:23], v[24:27], v[36:39], 0
    s_nop 7
    buffer_atomic_add_f32 v16, v7, s[8:11], 0 offen offset:0
    buffer_atomic_add_f32 v17, v7, s[8:11], 0 offen offset:128
    buffer_atomic_add_f32 v18, v7, s[8:11], 0 offen offset:256
    buffer_atomic_add_f32 v19, v7, s[8:11], 0 offen offset:384
    buffer_atomic_add_f32 v20, v7, s[8:11], 0 offen offset:64
    buffer_atomic_add_f32 v21, v7, s[8:11], 0 offen offset:192
    buffer_atomic_add_f32 v22, v7, s[8:11], 0 offen offset:320
    buffer_atomic_add_f32 v23, v7, s[8:11], 0 offen offset:448
    v_add_u32 v7, 2048, v7
    ds_read_b128 v[24:27], v6 offset:23552
    s_waitcnt lgkmcnt(0)
    v_mfma_f32_16x16x32_bf16 v[16:19], v[24:27], v[32:35], 0
    v_mfma_f32_16x16x32_bf16 v[20:23], v[24:27], v[36:39], 0
    s_nop 7
    buffer_atomic_add_f32 v16, v7, s[8:11], 0 offen offset:0
    buffer_atomic_add_f32 v17, v7, s[8:11], 0 offen offset:128
    buffer_atomic_add_f32 v18, v7, s[8:11], 0 offen offset:256
    buffer_atomic_add_f32 v19, v7, s[8:11], 0 offen offset:384
    buffer_atomic_add_f32 v20, v7, s[8:11], 0 offen offset:64
    buffer_atomic_add_f32 v21, v7, s[8:11], 0 offen offset:192
    buffer_atomic_add_f32 v22, v7, s[8:11], 0 offen offset:320
    buffer_atomic_add_f32 v23, v7, s[8:11], 0 offen offset:448
    v_add_u32 v7, 2048, v7
    ds_read_b128 v[24:27], v6 offset:24576
    s_waitcnt lgkmcnt(0)
    v_mfma_f32_16x16x32_bf16 v[16:19], v[24:27], v[32:35], 0
    v_mfma_f32_16x16x32_bf16 v[20:23], v[24:27], v[36:39], 0
    s_nop 7
    buffer_atomic_add_f32 v16, v7, s[8:11], 0 offen offset:0
    buffer_atomic_add_f32 v17, v7, s[8:11], 0 offen offset:128
    buffer_atomic_add_f32 v18, v7, s[8:11], 0 offen offset:256
    buffer_atomic_add_f32 v19, v7, s[8:11], 0 offen offset:384
    buffer_atomic_add_f32 v20, v7, s[8:11], 0 offen offset:64
    buffer_atomic_add_f32 v21, v7, s[8:11], 0 offen offset:192
    buffer_atomic_add_f32 v22, v7, s[8:11], 0 offen offset:320
    buffer_atomic_add_f32 v23, v7, s[8:11], 0 offen offset:448
    v_add_u32 v7, 2048, v7
    ds_read_b128 v[24:27], v6 offset:25600
    s_waitcnt lgkmcnt(0)
    v_mfma_f32_16x16x32_bf16 v[16:19], v[24:27], v[32:35], 0
    v_mfma_f32_16x16x32_bf16 v[20:23], v[24:27], v[36:39], 0
    s_nop 7
    buffer_atomic_add_f32 v16, v7, s[8:11], 0 offen offset:0
    buffer_atomic_add_f32 v17, v7, s[8:11], 0 offen offset:128
    buffer_atomic_add_f32 v18, v7, s[8:11], 0 offen offset:256
    buffer_atomic_add_f32 v19, v7, s[8:11], 0 offen offset:384
    buffer_atomic_add_f32 v20, v7, s[8:11], 0 offen offset:64
    buffer_atomic_add_f32 v21, v7, s[8:11], 0 offen offset:192
    buffer_atomic_add_f32 v22, v7, s[8:11], 0 offen offset:320
    buffer_atomic_add_f32 v23, v7, s[8:11], 0 offen offset:448
    v_add_u32 v7, 2048, v7
k2_end:
    s_endpgm
.globl k3_kernel
.p2align 8
.type k3_kernel,@function
k3_kernel:
    s_movk_i32 s90, 0x7fff
    s_cmp_ge_u32 s2, 128
    s_cbranch_scc1 k3_end
    s_load_dwordx2 s[8:9], s[0:1], 104
    s_waitcnt lgkmcnt(0)
    s_and_b32 s9, s9, 0xffff
    s_mov_b32 s10, 268435456
    s_mov_b32 s11, 0x00020000
    s_load_dwordx2 s[24:25], s[0:1], 88
    s_waitcnt lgkmcnt(0)
    s_and_b32 s25, s25, 0xffff
    s_mov_b32 s26, 3670016
    s_mov_b32 s27, 0x00020000
    v_and_b32 v1, 15, v0
    v_bfe_u32 v2, v0, 4, 2
    v_lshrrev_b32 v3, 6, v0
    s_nop 0
    v_readfirstlane_b32 s7, v3
    v_and_b32 v60, 48, v0
    v_or_b32 v60, 12, v60
    v_lshlrev_b32 v60, 2, v60
    s_lshl_b32 s3, s2, 15
    s_add_u32 s3, s3, 47185920
    v_lshlrev_b32 v4, 11, v1
    v_lshl_add_u32 v4, v2, 4, v4
    v_add_u32 v4, s3, v4
    v_lshlrev_b32 v5, 10, v2
    v_lshl_add_u32 v5, v1, 2, v5
    v_add_u32 v5, 46137344, v5
    v_mul_u32_u24 v7, 3648, v2
    v_lshl_add_u32 v7, v1, 1, v7
    s_lshl_b32 s6, s7, 2
    s_add_u32 s5, s6, 4
k3_h:
    s_lshl_b32 s3, s6, 7
    v_add_u32 v8, s3, v4
    s_lshl_b32 s3, s6, 13
    v_add_u32 v9, s3, v5
    v_mov_b32 v16, 0
    v_mov_b32 v17, 0
    v_mov_b32 v18, 0
    v_mov_b32 v19, 0
    v_mov_b32 v20, 0
    v_mov_b32 v21, 0
    v_mov_b32 v22, 0
    v_mov_b32 v23, 0
    buffer_load_dwordx4 v[24:27], v8, s[8:11], 0 offen offset:0
    v_mov_b32 v10, v9
    buffer_load_dword v32, v10, s[8:11], 0 offen offset:0
    buffer_load_dword v33, v10, s[8:11], 0 offen offset:128
    buffer_load_dword v34, v10, s[8:11], 0 offen offset:256
    buffer_load_dword v35, v10, s[8:11], 0 offen offset:384
    buffer_load_dword v36, v10, s[8:11], 0 offen offset:512
    buffer_load_dword v37, v10, s[8:11], 0 offen offset:640
    buffer_load_dword v38, v10, s[8:11], 0 offen offset:768
    buffer_load_dword v39, v10, s[8:11], 0 offen offset:896
    s_waitcnt vmcnt(0)
    v_cvt_pk_bf16_f32 v28, v32, v33
    v_cvt_pk_bf16_f32 v29, v34, v35
    v_cvt_pk_bf16_f32 v30, v36, v37
    v_cvt_pk_bf16_f32 v31, v38, v39
    s_nop 1
    v_mfma_f32_16x16x32_bf16 v[16:19], v[24:27], v[28:31], v[16:19]
    v_mov_b32 v10, v9
    buffer_load_dword v32, v10, s[8:11], 0 offen offset:64
    buffer_load_dword v33, v10, s[8:11], 0 offen offset:192
    buffer_load_dword v34, v10, s[8:11], 0 offen offset:320
    buffer_load_dword v35, v10, s[8:11], 0 offen offset:448
    buffer_load_dword v36, v10, s[8:11], 0 offen offset:576
    buffer_load_dword v37, v10, s[8:11], 0 offen offset:704
    buffer_load_dword v38, v10, s[8:11], 0 offen offset:832
    buffer_load_dword v39, v10, s[8:11], 0 offen offset:960
    s_waitcnt vmcnt(0)
    v_cvt_pk_bf16_f32 v28, v32, v33
    v_cvt_pk_bf16_f32 v29, v34, v35
    v_cvt_pk_bf16_f32 v30, v36, v37
    v_cvt_pk_bf16_f32 v31, v38, v39
    s_nop 1
    v_mfma_f32_16x16x32_bf16 v[20:23], v[24:27], v[28:31], v[20:23]
    buffer_load_dwordx4 v[24:27], v8, s[8:11], 0 offen offset:64
    v_add_u32 v10, 4096, v9
    buffer_load_dword v32, v10, s[8:11], 0 offen offset:0
    buffer_load_dword v33, v10, s[8:11], 0 offen offset:128
    buffer_load_dword v34, v10, s[8:11], 0 offen offset:256
    buffer_load_dword v35, v10, s[8:11], 0 offen offset:384
    buffer_load_dword v36, v10, s[8:11], 0 offen offset:512
    buffer_load_dword v37, v10, s[8:11], 0 offen offset:640
    buffer_load_dword v38, v10, s[8:11], 0 offen offset:768
    buffer_load_dword v39, v10, s[8:11], 0 offen offset:896
    s_waitcnt vmcnt(0)
    v_cvt_pk_bf16_f32 v28, v32, v33
    v_cvt_pk_bf16_f32 v29, v34, v35
    v_cvt_pk_bf16_f32 v30, v36, v37
    v_cvt_pk_bf16_f32 v31, v38, v39
    s_nop 1
    v_mfma_f32_16x16x32_bf16 v[16:19], v[24:27], v[28:31], v[16:19]
    v_add_u32 v10, 4096, v9
    buffer_load_dword v32, v10, s[8:11], 0 offen offset:64
    buffer_load_dword v33, v10, s[8:11], 0 offen offset:192
    buffer_load_dword v34, v10, s[8:11], 0 offen offset:320
    buffer_load_dword v35, v10, s[8:11], 0 offen offset:448
    buffer_load_dword v36, v10, s[8:11], 0 offen offset:576
    buffer_load_dword v37, v10, s[8:11], 0 offen offset:704
    buffer_load_dword v38, v10, s[8:11], 0 offen offset:832
    buffer_load_dword v39, v10, s[8:11], 0 offen offset:960
    s_waitcnt vmcnt(0)
    v_cvt_pk_bf16_f32 v28, v32, v33
    v_cvt_pk_bf16_f32 v29, v34, v35
    v_cvt_pk_bf16_f32 v30, v36, v37
    v_cvt_pk_bf16_f32 v31, v38, v39
    s_nop 1
    v_mfma_f32_16x16x32_bf16 v[20:23], v[24:27], v[28:31], v[20:23]
    s_nop 7
    s_mul_i32 s3, s6, 56
    v_add_u32 v10, s3, v7
    v_cmp_gt_u32 vcc, 12, v1
    ds_bpermute_b32 v32, v60, v20
    s_waitcnt lgkmcnt(0)
    v_bfe_u32 v40, v32, 16, 1
    v_add3_u32 v32, v32, v40, s90
    v_and_b32 v32, 0xffff0000, v32
    v_add_f32 v32, 0x358637bd, v32
    v_bfe_u32 v40, v32, 16, 1
    v_add3_u32 v32, v32, v40, s90
    v_and_b32 v32, 0xffff0000, v32
    v_rcp_f32 v32, v32
    v_bfe_u32 v40, v16, 16, 1
    v_add3_u32 v16, v16, v40, s90
    v_and_b32 v16, 0xffff0000, v16
    v_mul_f32 v41, v16, v32
    v_cvt_pk_bf16_f32 v41, v41, v41
    ds_write_b16 v10, v41 offset:0
    v_bfe_u32 v40, v20, 16, 1
    v_add3_u32 v20, v20, v40, s90
    v_and_b32 v20, 0xffff0000, v20
    v_mul_f32 v41, v20, v32
    v_cvt_pk_bf16_f32 v41, v41, v41
    s_and_saveexec_b64 s[22:23], vcc
    ds_write_b16 v10, v41 offset:32
    s_mov_b64 exec, s[22:23]
    ds_bpermute_b32 v33, v60, v21
    s_waitcnt lgkmcnt(0)
    v_bfe_u32 v40, v33, 16, 1
    v_add3_u32 v33, v33, v40, s90
    v_and_b32 v33, 0xffff0000, v33
    v_add_f32 v33, 0x358637bd, v33
    v_bfe_u32 v40, v33, 16, 1
    v_add3_u32 v33, v33, v40, s90
    v_and_b32 v33, 0xffff0000, v33
    v_rcp_f32 v33, v33
    v_bfe_u32 v40, v17, 16, 1
    v_add3_u32 v17, v17, v40, s90
    v_and_b32 v17, 0xffff0000, v17
    v_mul_f32 v41, v17, v33
    v_cvt_pk_bf16_f32 v41, v41, v41
    ds_write_b16 v10, v41 offset:912
    v_bfe_u32 v40, v21, 16, 1
    v_add3_u32 v21, v21, v40, s90
    v_and_b32 v21, 0xffff0000, v21
    v_mul_f32 v41, v21, v33
    v_cvt_pk_bf16_f32 v41, v41, v41
    s_and_saveexec_b64 s[22:23], vcc
    ds_write_b16 v10, v41 offset:944
    s_mov_b64 exec, s[22:23]
    ds_bpermute_b32 v34, v60, v22
    s_waitcnt lgkmcnt(0)
    v_bfe_u32 v40, v34, 16, 1
    v_add3_u32 v34, v34, v40, s90
    v_and_b32 v34, 0xffff0000, v34
    v_add_f32 v34, 0x358637bd, v34
    v_bfe_u32 v40, v34, 16, 1
    v_add3_u32 v34, v34, v40, s90
    v_and_b32 v34, 0xffff0000, v34
    v_rcp_f32 v34, v34
    v_bfe_u32 v40, v18, 16, 1
    v_add3_u32 v18, v18, v40, s90
    v_and_b32 v18, 0xffff0000, v18
    v_mul_f32 v41, v18, v34
    v_cvt_pk_bf16_f32 v41, v41, v41
    ds_write_b16 v10, v41 offset:1824
    v_bfe_u32 v40, v22, 16, 1
    v_add3_u32 v22, v22, v40, s90
    v_and_b32 v22, 0xffff0000, v22
    v_mul_f32 v41, v22, v34
    v_cvt_pk_bf16_f32 v41, v41, v41
    s_and_saveexec_b64 s[22:23], vcc
    ds_write_b16 v10, v41 offset:1856
    s_mov_b64 exec, s[22:23]
    ds_bpermute_b32 v35, v60, v23
    s_waitcnt lgkmcnt(0)
    v_bfe_u32 v40, v35, 16, 1
    v_add3_u32 v35, v35, v40, s90
    v_and_b32 v35, 0xffff0000, v35
    v_add_f32 v35, 0x358637bd, v35
    v_bfe_u32 v40, v35, 16, 1
    v_add3_u32 v35, v35, v40, s90
    v_and_b32 v35, 0xffff0000, v35
    v_rcp_f32 v35, v35
    v_bfe_u32 v40, v19, 16, 1
    v_add3_u32 v19, v19, v40, s90
    v_and_b32 v19, 0xffff0000, v19
    v_mul_f32 v41, v19, v35
    v_cvt_pk_bf16_f32 v41, v41, v41
    ds_write_b16 v10, v41 offset:2736
    v_bfe_u32 v40, v23, 16, 1
    v_add3_u32 v23, v23, v40, s90
    v_and_b32 v23, 0xffff0000, v23
    v_mul_f32 v41, v23, v35
    v_cvt_pk_bf16_f32 v41, v41, v41
    s_and_saveexec_b64 s[22:23], vcc
    ds_write_b16 v10, v41 offset:2768
    s_mov_b64 exec, s[22:23]
    s_add_u32 s6, s6, 1
    s_cmp_lt_u32 s6, s5
    s_cbranch_scc1 k3_h
    s_waitcnt lgkmcnt(0)
    s_barrier
    v_mul_u32_u24 v4, 912, v1
    v_lshl_add_u32 v4, v2, 4, v4
    s_mul_i32 s3, s7, 100352
    s_add_u32 s3, s3, 44040192
    v_mul_u32_u24 v5, 896, v1
    v_lshl_add_u32 v5, v2, 4, v5
    v_add_u32 v5, s3, v5
    s_mul_i32 s3, s2, 28672
    s_mul_i32 s4, s7, 224
    s_add_u32 s3, s3, s4
    s_add_u32 s3, s3, 896
    v_mul_u32_u24 v6, 7168, v2
    v_lshl_add_u32 v6, v1, 1, v6
    v_add_u32 v6, s3, v6
    s_mov_b32 s6, 0
k3_t:
    v_mov_b32 v16, 0
    v_mov_b32 v17, 0
    v_mov_b32 v18, 0
    v_mov_b32 v19, 0
    buffer_load_dwordx4 v[64:67], v5, s[8:11], 0 offen offset:0
    buffer_load_dwordx4 v[68:71], v5, s[8:11], 0 offen offset:64
    buffer_load_dwordx4 v[72:75], v5, s[8:11], 0 offen offset:128
    buffer_load_dwordx4 v[76:79], v5, s[8:11], 0 offen offset:192
    buffer_load_dwordx4 v[80:83], v5, s[8:11], 0 offen offset:256
    buffer_load_dwordx4 v[84:87], v5, s[8:11], 0 offen offset:320
    buffer_load_dwordx4 v[88:91], v5, s[8:11], 0 offen offset:384
    buffer_load_dwordx4 v[92:95], v5, s[8:11], 0 offen offset:448
    buffer_load_dwordx4 v[96:99], v5, s[8:11], 0 offen offset:512
    buffer_load_dwordx4 v[100:103], v5, s[8:11], 0 offen offset:576
    buffer_load_dwordx4 v[104:107], v5, s[8:11], 0 offen offset:640
    buffer_load_dwordx4 v[108:111], v5, s[8:11], 0 offen offset:704
    buffer_load_dwordx4 v[112:115], v5, s[8:11], 0 offen offset:768
    buffer_load_dwordx4 v[116:119], v5, s[8:11], 0 offen offset:832
    ds_read_b128 v[24:27], v4 offset:0
    s_waitcnt vmcnt(13) lgkmcnt(0)
    v_mfma_f32_16x16x32_bf16 v[16:19], v[24:27], v[64:67], v[16:19]
    ds_read_b128 v[24:27], v4 offset:64
    s_waitcnt vmcnt(12) lgkmcnt(0)
    v_mfma_f32_16x16x32_bf16 v[16:19], v[24:27], v[68:71], v[16:19]
    ds_read_b128 v[24:27], v4 offset:128
    s_waitcnt vmcnt(11) lgkmcnt(0)
    v_mfma_f32_16x16x32_bf16 v[16:19], v[24:27], v[72:75], v[16:19]
    ds_read_b128 v[24:27], v4 offset:192
    s_waitcnt vmcnt(10) lgkmcnt(0)
    v_mfma_f32_16x16x32_bf16 v[16:19], v[24:27], v[76:79], v[16:19]
    ds_read_b128 v[24:27], v4 offset:256
    s_waitcnt vmcnt(9) lgkmcnt(0)
    v_mfma_f32_16x16x32_bf16 v[16:19], v[24:27], v[80:83], v[16:19]
    ds_read_b128 v[24:27], v4 offset:320
    s_waitcnt vmcnt(8) lgkmcnt(0)
    v_mfma_f32_16x16x32_bf16 v[16:19], v[24:27], v[84:87], v[16:19]
    ds_read_b128 v[24:27], v4 offset:384
    s_waitcnt vmcnt(7) lgkmcnt(0)
    v_mfma_f32_16x16x32_bf16 v[16:19], v[24:27], v[88:91], v[16:19]
    ds_read_b128 v[24:27], v4 offset:448
    s_waitcnt vmcnt(6) lgkmcnt(0)
    v_mfma_f32_16x16x32_bf16 v[16:19], v[24:27], v[92:95], v[16:19]
    ds_read_b128 v[24:27], v4 offset:512
    s_waitcnt vmcnt(5) lgkmcnt(0)
    v_mfma_f32_16x16x32_bf16 v[16:19], v[24:27], v[96:99], v[16:19]
    ds_read_b128 v[24:27], v4 offset:576
    s_waitcnt vmcnt(4) lgkmcnt(0)
    v_mfma_f32_16x16x32_bf16 v[16:19], v[24:27], v[100:103], v[16:19]
    ds_read_b128 v[24:27], v4 offset:640
    s_waitcnt vmcnt(3) lgkmcnt(0)
    v_mfma_f32_16x16x32_bf16 v[16:19], v[24:27], v[104:107], v[16:19]
    ds_read_b128 v[24:27], v4 offset:704
    s_waitcnt vmcnt(2) lgkmcnt(0)
    v_mfma_f32_16x16x32_bf16 v[16:19], v[24:27], v[108:111], v[16:19]
    ds_read_b128 v[24:27], v4 offset:768
    s_waitcnt vmcnt(1) lgkmcnt(0)
    v_mfma_f32_16x16x32_bf16 v[16:19], v[24:27], v[112:115], v[16:19]
    ds_read_b128 v[24:27], v4 offset:832
    s_waitcnt vmcnt(0) lgkmcnt(0)
    v_mfma_f32_16x16x32_bf16 v[16:19], v[24:27], v[116:119], v[16:19]
    s_nop 7
    v_cvt_pk_bf16_f32 v20, v16, v16
    v_add_u32 v21, 0, v6
    buffer_store_short v20, v21, s[24:27], 0 offen
    v_cvt_pk_bf16_f32 v20, v17, v17
    v_add_u32 v21, 1792, v6
    buffer_store_short v20, v21, s[24:27], 0 offen
    v_cvt_pk_bf16_f32 v20, v18, v18
    v_add_u32 v21, 3584, v6
    buffer_store_short v20, v21, s[24:27], 0 offen
    v_cvt_pk_bf16_f32 v20, v19, v19
    v_add_u32 v21, 5376, v6
    buffer_store_short v20, v21, s[24:27], 0 offen
    v_add_u32 v5, 14336, v5
    v_add_u32 v6, 32, v6
    s_add_u32 s6, s6, 1
    s_cmp_lt_u32 s6, 7
    s_cbranch_scc1 k3_t
k3_end:
    s_endpgm
.section .rodata,"a"
.p2align 6
.amdhsa_kernel k1_kernel
  .amdhsa_next_free_vgpr 128
  .amdhsa_next_free_sgpr 96
  .amdhsa_accum_offset 128
  .amdhsa_group_segment_fixed_size 0
  .amdhsa_kernarg_size 112
  .amdhsa_user_sgpr_count 2
  .amdhsa_user_sgpr_kernarg_segment_ptr 1
  .amdhsa_system_sgpr_workgroup_id_x 1
.end_amdhsa_kernel
.p2align 6
.amdhsa_kernel k2_kernel
  .amdhsa_next_free_vgpr 160
  .amdhsa_next_free_sgpr 96
  .amdhsa_accum_offset 160
  .amdhsa_group_segment_fixed_size 0
  .amdhsa_kernarg_size 112
  .amdhsa_user_sgpr_count 2
  .amdhsa_user_sgpr_kernarg_segment_ptr 1
  .amdhsa_system_sgpr_workgroup_id_x 1
.end_amdhsa_kernel
.p2align 6
.amdhsa_kernel k3_kernel
  .amdhsa_next_free_vgpr 128
  .amdhsa_next_free_sgpr 96
  .amdhsa_accum_offset 128
  .amdhsa_group_segment_fixed_size 0
  .amdhsa_kernarg_size 112
  .amdhsa_user_sgpr_count 2
  .amdhsa_user_sgpr_kernarg_segment_ptr 1
  .amdhsa_system_sgpr_workgroup_id_x 1
.end_amdhsa_kernel
```
